```python
import torch

def _softmax(x, axis=-1):
    return torch.softmax(x, dim=axis)
def _gelu(x):
    return torch.nn.functional.gelu(x, approximate="tanh")
def _silu(x):
    return torch.nn.functional.silu(x)
def _sigmoid(x):
    return torch.sigmoid(x)
def _layernorm(x, axis=-1, eps=1e-5):
    m = x.mean(dim=axis, keepdim=True)
    v = x.var(dim=axis, keepdim=True, unbiased=False)
    return (x - m) / torch.sqrt(v + eps)
def _scatter_add(tgt, idx, src, axis=0):
    return tgt.clone().index_add_(axis, idx, src)
def _segment_sum(src, seg, n):
    out = torch.zeros((n,) + src.shape[1:], dtype=src.dtype)
    return out.index_add_(0, seg, src)
def _pad(x, pw):
    flat = tuple(v for pair in reversed(pw) for v in pair)
    return torch.nn.functional.pad(x, flat)

kernel_name = 'standalone__gqa_softmax__near_ridge'

def setup_inputs():

    _w = (lambda a: (lambda t: t.to(torch.bfloat16) if t.is_floating_point() else t)(torch.as_tensor(a)))
    B, Hq, Hkv, Sq, Sk, D = 16, 16, 8, 384, 384, 256
    return {
        "q": _w((lambda *s: torch.randn(*s, dtype=torch.bfloat16) * 0.8)(B, Hq, Sq, D)),
        "k": _w((lambda *s: torch.randn(*s, dtype=torch.bfloat16) * 0.8)(B, Hkv, Sk, D)),
        "v": _w((lambda *s: torch.randn(*s, dtype=torch.bfloat16) * 0.05)(B, Hkv, Sk, D)),
    }

def reference(q, k, v):
    B, Hq, Sq, D = q.shape
    Hkv = k.shape[1]
    rep = Hq // Hkv
    k = (lambda x, n, axis: torch.repeat_interleave(x, n, dim=axis))(k, rep, axis=1)
    v = (lambda x, n, axis: torch.repeat_interleave(x, n, dim=axis))(v, rep, axis=1)
    scale = D ** -0.5
    scores = torch.einsum("bhqd,bhkd->bhqk", q, k) * scale
    p = _softmax(scores, axis=-1)
    return torch.einsum("bhqk,bhkd->bhqd", p, v)
```

```asm
; @launch grid=(256,1,1) block=(256,1,1) lds=162816
.amdgcn_target "amdgcn-amd-amdhsa--gfx950"
.text
.globl standalone__gqa_softmax__near_ridge_kernel
.p2align 8
.type standalone__gqa_softmax__near_ridge_kernel,@function
standalone__gqa_softmax__near_ridge_kernel:
  s_cmp_ge_u32 s2, 256
  s_cbranch_scc1 L_done
  s_load_dwordx4 s[4:7], s[0:1], 0
  s_load_dwordx4 s[44:47], s[0:1], 16
  s_and_b32 s3, s2, 7
  s_lshr_b32 s31, s2, 3
  s_lshl_b32 s3, s3, 5
  s_add_u32 s3, s3, s31
  s_lshr_b32 s31, s3, 1
  s_mul_i32 s32, s3, 196608
  s_mul_i32 s33, s31, 196608
  v_lshrrev_b32 v49, 6, v0
  v_and_b32 v48, 63, v0
  v_and_b32 v50, 15, v0
  v_bfe_u32 v51, v0, 4, 2
  v_readfirstlane_b32 s25, v49
  v_and_b32 v52, 31, v48
  v_lshrrev_b32 v53, 5, v48
  v_xor_b32 v52, v52, v53
  v_lshlrev_b32 v52, 4, v52
  v_lshl_add_u32 v52, v53, 9, v52
  v_lshl_add_u32 v113, v49, 11, v52
  v_lshrrev_b32 v52, 3, v48
  v_and_b32 v53, 7, v48
  v_xor_b32 v54, v53, v51
  v_lshlrev_b32 v54, 4, v54
  v_lshl_add_u32 v54, v52, 9, v54
  v_mul_u32_u24 v122, 49152, v49
  v_add_u32 v122, v122, v54
  v_xor_b32 v123, 64, v122
  s_getpc_b64 s[92:93]
  s_lshr_b32 s94, s2, 3
  s_lshl_b32 s94, s94, 10
  v_lshlrev_b32 v55, 2, v0
  v_add_u32 v55, s94, v55
  v_min_u32 v55, 19656, v55
  global_load_dword v255, v55, s[92:93]
  s_waitcnt lgkmcnt(0)
  s_add_u32 s8, s4, s32
  s_addc_u32 s9, s5, 0
  s_mov_b32 s10, 196608
  s_mov_b32 s11, 0x20000
  s_add_u32 s12, s6, s33
  s_addc_u32 s13, s7, 0
  s_mov_b32 s14, 196608
  s_mov_b32 s15, 0x20000
  s_mul_i32 s29, s25, 2112
  s_add_u32 s29, s29, 1024
  s_mul_i32 s34, s25, 14336
  s_add_u32 s34, s34, 105472
  s_add_u32 m0, s29, 33792
  s_mov_b32 s31, 0
  buffer_load_dwordx4 v113, s[8:11], s31 offen offset:0 nt lds
  s_add_u32 m0, s29, 33824
  s_mov_b32 s31, 0
  buffer_load_dwordx4 v113, s[8:11], s31 offen offset:1024 nt lds
  s_add_u32 m0, s34, 0
  s_mov_b32 s31, 0
  buffer_load_dwordx4 v122, s[12:15], s31 offen offset:0 nt lds
  s_add_u32 m0, s34, 1024
  s_mov_b32 s31, 4096
  buffer_load_dwordx4 v123, s[12:15], s31 offen offset:0 nt lds
  s_add_u32 m0, s34, 2048
  s_mov_b32 s31, 8192
  buffer_load_dwordx4 v122, s[12:15], s31 offen offset:0 nt lds
  s_add_u32 m0, s34, 3072
  s_mov_b32 s31, 12288
  buffer_load_dwordx4 v123, s[12:15], s31 offen offset:0 nt lds
  s_add_u32 m0, s34, 4096
  s_mov_b32 s31, 16384
  buffer_load_dwordx4 v122, s[12:15], s31 offen offset:0 nt lds
  s_add_u32 m0, s34, 5120
  s_mov_b32 s31, 20480
  buffer_load_dwordx4 v123, s[12:15], s31 offen offset:0 nt lds
  s_add_u32 m0, s34, 6144
  s_mov_b32 s31, 24576
  buffer_load_dwordx4 v122, s[12:15], s31 offen offset:0 nt lds
  s_add_u32 m0, s34, 7168
  s_mov_b32 s31, 28672
  buffer_load_dwordx4 v123, s[12:15], s31 offen offset:0 nt lds
  s_add_u32 m0, s34, 8192
  s_mov_b32 s31, 32768
  buffer_load_dwordx4 v122, s[12:15], s31 offen offset:0 nt lds
  s_add_u32 m0, s34, 9216
  s_mov_b32 s31, 36864
  buffer_load_dwordx4 v123, s[12:15], s31 offen offset:0 nt lds
  s_add_u32 m0, s34, 10240
  s_mov_b32 s31, 40960
  buffer_load_dwordx4 v122, s[12:15], s31 offen offset:0 nt lds
  s_add_u32 m0, s34, 11264
  s_mov_b32 s31, 45056
  buffer_load_dwordx4 v123, s[12:15], s31 offen offset:0 nt lds
  s_add_u32 s16, s44, s33
  s_addc_u32 s17, s45, 0
  s_mov_b32 s18, 196608
  s_mov_b32 s19, 0x20000
  s_add_u32 s20, s46, s32
  s_addc_u32 s21, s47, 0
  s_mov_b32 s22, 196608
  s_mov_b32 s23, 0x20000
  s_mov_b32 s24, 0x3db8aa3b
  s_mov_b32 s36, 196608
  v_and_b32 v54, 1, v51
  v_lshlrev_b32 v54, 2, v54
  v_xor_b32 v54, v53, v54
  v_lshlrev_b32 v54, 4, v54
  v_lshl_add_u32 v54, v52, 9, v54
  v_lshl_add_u32 v119, v49, 7, v54
  v_lshrrev_b32 v52, 1, v50
  v_mul_u32_u24 v52, 1056, v52
  v_and_b32 v53, 1, v50
  v_lshl_add_u32 v52, v53, 9, v52
  v_xor_b32 v53, v53, v51
  v_lshl_add_u32 v52, v53, 4, v52
  v_add_u32 v108, 34816, v52
  v_lshlrev_b32 v52, 4, v48
  v_add_u32 v109, 51712, v52
  v_mul_u32_u24 v53, 3072, v49
  v_add_u32 v110, v109, v53
  v_lshlrev_b32 v111, 4, v50
  v_lshl_add_u32 v112, v49, 2, v111
  v_lshlrev_b32 v52, 9, v50
  v_lshl_add_u32 v52, v51, 4, v52
  v_lshl_add_u32 v114, v49, 7, v52
  v_and_b32 v52, 7, v50
  v_lshlrev_b32 v52, 9, v52
  v_lshrrev_b32 v53, 3, v50
  v_lshl_add_u32 v52, v53, 6, v52
  v_lshl_add_u32 v52, v51, 4, v52
  v_lshl_add_u32 v114, v49, 7, v52
  v_xor_b32 v52, 64, v114
  v_add_u32 v127, 4096, v52
  s_mov_b32 s88, 0xff00ff00
  s_mov_b32 s89, 0xff00ff00
  v_lshrrev_b32 v52, 1, v50
  v_xor_b32 v52, v52, v51
  v_lshlrev_b32 v52, 4, v52
  v_lshl_add_u32 v52, v50, 7, v52
  v_xor_b32 v53, 64, v52
  v_add_u32 v124, s34, v52
  v_add_u32 v125, s34, v53
  v_lshrrev_b32 v52, 2, v50
  v_lshl_add_u32 v52, v51, 2, v52
  v_and_b32 v53, 3, v50
  v_bfe_u32 v54, v52, 1, 1
  v_lshl_add_u32 v53, v54, 2, v53
  v_lshlrev_b32 v53, 4, v53
  v_lshl_add_u32 v53, v52, 7, v53
  v_xor_b32 v54, 64, v53
  v_add_u32 v120, s34, v53
  v_add_u32 v121, s34, v54
  v_mov_b32 v96, 0x3f803f80
  v_mov_b32 v97, 0x3f803f80
  v_mov_b32 v98, 0x3f803f80
  v_mov_b32 v99, 0x3f803f80
  s_mov_b32 s28, 33792
  s_waitcnt vmcnt(8)
  ds_read_b128 a[0:3], v124 offset:0
  ds_read_b128 a[4:7], v125 offset:0
  ds_read_b128 a[32:35], v124 offset:2048
  ds_read_b128 a[36:39], v125 offset:2048
  s_barrier
  s_waitcnt lgkmcnt(0)
  s_add_u32 m0, s34, 0
  s_mov_b32 s31, 128
  buffer_load_dwordx4 v122, s[12:15], s31 offen offset:0 nt lds
  s_add_u32 m0, s34, 1024
  s_mov_b32 s31, 4224
  buffer_load_dwordx4 v123, s[12:15], s31 offen offset:0 nt lds
  s_add_u32 m0, s34, 2048
  s_mov_b32 s31, 8320
  buffer_load_dwordx4 v122, s[12:15], s31 offen offset:0 nt lds
  s_add_u32 m0, s34, 3072
  s_mov_b32 s31, 12416
  buffer_load_dwordx4 v123, s[12:15], s31 offen offset:0 nt lds
  s_waitcnt vmcnt(8)
  ds_read_b128 a[64:67], v124 offset:4096
  ds_read_b128 a[68:71], v125 offset:4096
  ds_read_b128 a[96:99], v124 offset:6144
  ds_read_b128 a[100:103], v125 offset:6144
  s_waitcnt lgkmcnt(0)
  s_add_u32 m0, s34, 4096
  s_mov_b32 s31, 16512
  buffer_load_dwordx4 v122, s[12:15], s31 offen offset:0 nt lds
  s_add_u32 m0, s34, 5120
  s_mov_b32 s31, 20608
  buffer_load_dwordx4 v123, s[12:15], s31 offen offset:0 nt lds
  s_add_u32 m0, s34, 6144
  s_mov_b32 s31, 24704
  buffer_load_dwordx4 v122, s[12:15], s31 offen offset:0 nt lds
  s_add_u32 m0, s34, 7168
  s_mov_b32 s31, 28800
  buffer_load_dwordx4 v123, s[12:15], s31 offen offset:0 nt lds
  s_waitcnt vmcnt(8)
  ds_read_b128 a[128:131], v124 offset:8192
  ds_read_b128 a[132:135], v125 offset:8192
  ds_read_b128 a[160:163], v124 offset:10240
  ds_read_b128 a[164:167], v125 offset:10240
  ds_read_b128 v[64:67], v108 offset:0
  ds_read_b128 v[68:71], v108 offset:64
  s_waitcnt lgkmcnt(2)
  s_add_u32 m0, s34, 8192
  s_mov_b32 s31, 32896
  buffer_load_dwordx4 v122, s[12:15], s31 offen offset:0 nt lds
  s_add_u32 m0, s34, 9216
  s_mov_b32 s31, 36992
  buffer_load_dwordx4 v123, s[12:15], s31 offen offset:0 nt lds
  s_add_u32 m0, s34, 10240
  s_mov_b32 s31, 41088
  buffer_load_dwordx4 v122, s[12:15], s31 offen offset:0 nt lds
  s_add_u32 m0, s34, 11264
  s_mov_b32 s31, 45184
  buffer_load_dwordx4 v123, s[12:15], s31 offen offset:0 nt lds
  s_waitcnt lgkmcnt(1)
  v_mfma_f32_16x16x32_bf16 v[0:3], a[0:3], v[64:67], 0
  s_waitcnt lgkmcnt(0)
  v_mfma_f32_16x16x32_bf16 v[0:3], a[4:7], v[68:71], v[0:3]
  v_mfma_f32_16x16x32_bf16 v[4:7], a[32:35], v[64:67], 0
  v_mfma_f32_16x16x32_bf16 v[4:7], a[36:39], v[68:71], v[4:7]
  v_mfma_f32_16x16x32_bf16 v[8:11], a[64:67], v[64:67], 0
  v_mfma_f32_16x16x32_bf16 v[8:11], a[68:71], v[68:71], v[8:11]
  v_mfma_f32_16x16x32_bf16 v[12:15], a[96:99], v[64:67], 0
  v_mfma_f32_16x16x32_bf16 v[12:15], a[100:103], v[68:71], v[12:15]
  v_mfma_f32_16x16x32_bf16 v[16:19], a[128:131], v[64:67], 0
  v_mfma_f32_16x16x32_bf16 v[16:19], a[132:135], v[68:71], v[16:19]
  v_mfma_f32_16x16x32_bf16 v[20:23], a[160:163], v[64:67], 0
  v_mfma_f32_16x16x32_bf16 v[20:23], a[164:167], v[68:71], v[20:23]
  s_waitcnt vmcnt(8)
  ds_read_b128 a[8:11], v124 offset:0
  ds_read_b128 a[12:15], v125 offset:0
  ds_read_b128 a[40:43], v124 offset:2048
  ds_read_b128 a[44:47], v125 offset:2048
  s_waitcnt lgkmcnt(0)
  s_add_u32 m0, s34, 0
  s_mov_b32 s31, 256
  buffer_load_dwordx4 v122, s[12:15], s31 offen offset:0 nt lds
  s_add_u32 m0, s34, 1024
  s_mov_b32 s31, 4352
  buffer_load_dwordx4 v123, s[12:15], s31 offen offset:0 nt lds
  s_add_u32 m0, s34, 2048
  s_mov_b32 s31, 8448
  buffer_load_dwordx4 v122, s[12:15], s31 offen offset:0 nt lds
  s_add_u32 m0, s34, 3072
  s_mov_b32 s31, 12544
  buffer_load_dwordx4 v123, s[12:15], s31 offen offset:0 nt lds
  s_waitcnt vmcnt(8)
  ds_read_b128 a[72:75], v124 offset:4096
  ds_read_b128 a[76:79], v125 offset:4096
  ds_read_b128 a[104:107], v124 offset:6144
  ds_read_b128 a[108:111], v125 offset:6144
  s_waitcnt lgkmcnt(0)
  s_add_u32 m0, s34, 4096
  s_mov_b32 s31, 16640
  buffer_load_dwordx4 v122, s[12:15], s31 offen offset:0 nt lds
  s_add_u32 m0, s34, 5120
  s_mov_b32 s31, 20736
  buffer_load_dwordx4 v123, s[12:15], s31 offen offset:0 nt lds
  s_add_u32 m0, s34, 6144
  s_mov_b32 s31, 24832
  buffer_load_dwordx4 v122, s[12:15], s31 offen offset:0 nt lds
  s_add_u32 m0, s34, 7168
  s_mov_b32 s31, 28928
  buffer_load_dwordx4 v123, s[12:15], s31 offen offset:0 nt lds
  s_waitcnt vmcnt(8)
  ds_read_b128 a[136:139], v124 offset:8192
  ds_read_b128 a[140:143], v125 offset:8192
  ds_read_b128 a[168:171], v124 offset:10240
  ds_read_b128 a[172:175], v125 offset:10240
  ds_read_b128 v[64:67], v108 offset:128
  ds_read_b128 v[68:71], v108 offset:192
  s_waitcnt lgkmcnt(2)
  s_add_u32 m0, s34, 8192
  s_mov_b32 s31, 33024
  buffer_load_dwordx4 v122, s[12:15], s31 offen offset:0 nt lds
  s_add_u32 m0, s34, 9216
  s_mov_b32 s31, 37120
  buffer_load_dwordx4 v123, s[12:15], s31 offen offset:0 nt lds
  s_add_u32 m0, s34, 10240
  s_mov_b32 s31, 41216
  buffer_load_dwordx4 v122, s[12:15], s31 offen offset:0 nt lds
  s_add_u32 m0, s34, 11264
  s_mov_b32 s31, 45312
  buffer_load_dwordx4 v123, s[12:15], s31 offen offset:0 nt lds
  s_waitcnt lgkmcnt(1)
  v_mfma_f32_16x16x32_bf16 v[0:3], a[8:11], v[64:67], v[0:3]
  s_waitcnt lgkmcnt(0)
  v_mfma_f32_16x16x32_bf16 v[0:3], a[12:15], v[68:71], v[0:3]
  v_mfma_f32_16x16x32_bf16 v[4:7], a[40:43], v[64:67], v[4:7]
  v_mfma_f32_16x16x32_bf16 v[4:7], a[44:47], v[68:71], v[4:7]
  v_mfma_f32_16x16x32_bf16 v[8:11], a[72:75], v[64:67], v[8:11]
  v_mfma_f32_16x16x32_bf16 v[8:11], a[76:79], v[68:71], v[8:11]
  v_mfma_f32_16x16x32_bf16 v[12:15], a[104:107], v[64:67], v[12:15]
  v_mfma_f32_16x16x32_bf16 v[12:15], a[108:111], v[68:71], v[12:15]
  v_mfma_f32_16x16x32_bf16 v[16:19], a[136:139], v[64:67], v[16:19]
  v_mfma_f32_16x16x32_bf16 v[16:19], a[140:143], v[68:71], v[16:19]
  v_mfma_f32_16x16x32_bf16 v[20:23], a[168:171], v[64:67], v[20:23]
  v_mfma_f32_16x16x32_bf16 v[20:23], a[172:175], v[68:71], v[20:23]
  s_waitcnt vmcnt(8)
  ds_read_b128 a[16:19], v124 offset:0
  ds_read_b128 a[20:23], v125 offset:0
  ds_read_b128 a[48:51], v124 offset:2048
  ds_read_b128 a[52:55], v125 offset:2048
  s_waitcnt lgkmcnt(0)
  s_add_u32 m0, s34, 0
  s_mov_b32 s31, 384
  buffer_load_dwordx4 v122, s[12:15], s31 offen offset:0 nt lds
  s_add_u32 m0, s34, 1024
  s_mov_b32 s31, 4480
  buffer_load_dwordx4 v123, s[12:15], s31 offen offset:0 nt lds
  s_add_u32 m0, s34, 2048
  s_mov_b32 s31, 8576
  buffer_load_dwordx4 v122, s[12:15], s31 offen offset:0 nt lds
  s_add_u32 m0, s34, 3072
  s_mov_b32 s31, 12672
  buffer_load_dwordx4 v123, s[12:15], s31 offen offset:0 nt lds
  s_waitcnt vmcnt(8)
  ds_read_b128 a[80:83], v124 offset:4096
  ds_read_b128 a[84:87], v125 offset:4096
  ds_read_b128 a[112:115], v124 offset:6144
  ds_read_b128 a[116:119], v125 offset:6144
  s_waitcnt lgkmcnt(0)
  s_add_u32 m0, s34, 4096
  s_mov_b32 s31, 16768
  buffer_load_dwordx4 v122, s[12:15], s31 offen offset:0 nt lds
  s_add_u32 m0, s34, 5120
  s_mov_b32 s31, 20864
  buffer_load_dwordx4 v123, s[12:15], s31 offen offset:0 nt lds
  s_add_u32 m0, s34, 6144
  s_mov_b32 s31, 24960
  buffer_load_dwordx4 v122, s[12:15], s31 offen offset:0 nt lds
  s_add_u32 m0, s34, 7168
  s_mov_b32 s31, 29056
  buffer_load_dwordx4 v123, s[12:15], s31 offen offset:0 nt lds
  s_waitcnt vmcnt(8)
  ds_read_b128 a[144:147], v124 offset:8192
  ds_read_b128 a[148:151], v125 offset:8192
  ds_read_b128 a[176:179], v124 offset:10240
  ds_read_b128 a[180:183], v125 offset:10240
  ds_read_b128 v[64:67], v108 offset:256
  ds_read_b128 v[68:71], v108 offset:320
  s_waitcnt lgkmcnt(2)
  s_add_u32 m0, s34, 8192
  s_mov_b32 s31, 33152
  buffer_load_dwordx4 v122, s[12:15], s31 offen offset:0 nt lds
  s_add_u32 m0, s34, 9216
  s_mov_b32 s31, 37248
  buffer_load_dwordx4 v123, s[12:15], s31 offen offset:0 nt lds
  s_add_u32 m0, s34, 10240
  s_mov_b32 s31, 41344
  buffer_load_dwordx4 v122, s[12:15], s31 offen offset:0 nt lds
  s_add_u32 m0, s34, 11264
  s_mov_b32 s31, 45440
  buffer_load_dwordx4 v123, s[12:15], s31 offen offset:0 nt lds
  s_waitcnt lgkmcnt(1)
  v_mfma_f32_16x16x32_bf16 v[0:3], a[16:19], v[64:67], v[0:3]
  s_waitcnt lgkmcnt(0)
  v_mfma_f32_16x16x32_bf16 v[0:3], a[20:23], v[68:71], v[0:3]
  v_mfma_f32_16x16x32_bf16 v[4:7], a[48:51], v[64:67], v[4:7]
  v_mfma_f32_16x16x32_bf16 v[4:7], a[52:55], v[68:71], v[4:7]
  v_mfma_f32_16x16x32_bf16 v[8:11], a[80:83], v[64:67], v[8:11]
  v_mfma_f32_16x16x32_bf16 v[8:11], a[84:87], v[68:71], v[8:11]
  v_mfma_f32_16x16x32_bf16 v[12:15], a[112:115], v[64:67], v[12:15]
  v_mfma_f32_16x16x32_bf16 v[12:15], a[116:119], v[68:71], v[12:15]
  v_mfma_f32_16x16x32_bf16 v[16:19], a[144:147], v[64:67], v[16:19]
  v_mfma_f32_16x16x32_bf16 v[16:19], a[148:151], v[68:71], v[16:19]
  v_mfma_f32_16x16x32_bf16 v[20:23], a[176:179], v[64:67], v[20:23]
  v_mfma_f32_16x16x32_bf16 v[20:23], a[180:183], v[68:71], v[20:23]
  s_waitcnt vmcnt(8)
  ds_read_b128 a[24:27], v124 offset:0
  ds_read_b128 a[28:31], v125 offset:0
  ds_read_b128 a[56:59], v124 offset:2048
  ds_read_b128 a[60:63], v125 offset:2048
  s_waitcnt lgkmcnt(0)
  s_add_u32 m0, s29, 42240
  s_mov_b32 s31, 8192
  buffer_load_dwordx4 v113, s[8:11], s31 offen offset:0 nt lds
  s_add_u32 m0, s29, 42272
  s_mov_b32 s31, 8192
  buffer_load_dwordx4 v113, s[8:11], s31 offen offset:1024 nt lds
  s_add_u32 m0, s29, 50688
  s_mov_b32 s31, 16384
  buffer_load_dwordx4 v113, s[8:11], s31 offen offset:0 nt lds
  s_add_u32 m0, s29, 50720
  s_mov_b32 s31, 16384
  buffer_load_dwordx4 v113, s[8:11], s31 offen offset:1024 nt lds
  s_waitcnt vmcnt(8)
  ds_read_b128 a[88:91], v124 offset:4096
  ds_read_b128 a[92:95], v125 offset:4096
  ds_read_b128 a[120:123], v124 offset:6144
  ds_read_b128 a[124:127], v125 offset:6144
  s_waitcnt lgkmcnt(0)
  s_add_u32 m0, s34, 12288
  s_mov_b32 s31, 0
  buffer_load_dwordx4 v119, s[16:19], s31 offen offset:0 nt lds
  s_add_u32 m0, s34, 13312
  s_mov_b32 s31, 4096
  buffer_load_dwordx4 v119, s[16:19], s31 offen offset:0 nt lds
  s_add_u32 m0, s34, 0
  s_mov_b32 s31, 8192
  buffer_load_dwordx4 v119, s[16:19], s31 offen offset:0 nt lds
  s_add_u32 m0, s34, 1024
  s_mov_b32 s31, 12288
  buffer_load_dwordx4 v119, s[16:19], s31 offen offset:0 nt lds
  s_waitcnt vmcnt(8)
  ds_read_b128 a[152:155], v124 offset:8192
  ds_read_b128 a[156:159], v125 offset:8192
  ds_read_b128 a[184:187], v124 offset:10240
  ds_read_b128 a[188:191], v125 offset:10240
  ds_read_b128 v[64:67], v108 offset:384
  ds_read_b128 v[68:71], v108 offset:448
  s_waitcnt lgkmcnt(1)
  v_mfma_f32_16x16x32_bf16 v[0:3], a[24:27], v[64:67], v[0:3]
  s_waitcnt lgkmcnt(0)
  v_mfma_f32_16x16x32_bf16 v[0:3], a[28:31], v[68:71], v[0:3]
  v_mfma_f32_16x16x32_bf16 v[4:7], a[56:59], v[64:67], v[4:7]
  v_mfma_f32_16x16x32_bf16 v[4:7], a[60:63], v[68:71], v[4:7]
  v_mfma_f32_16x16x32_bf16 v[8:11], a[88:91], v[64:67], v[8:11]
  v_mfma_f32_16x16x32_bf16 v[8:11], a[92:95], v[68:71], v[8:11]
  v_mfma_f32_16x16x32_bf16 v[12:15], a[120:123], v[64:67], v[12:15]
  v_mfma_f32_16x16x32_bf16 v[12:15], a[124:127], v[68:71], v[12:15]
  v_mfma_f32_16x16x32_bf16 v[16:19], a[152:155], v[64:67], v[16:19]
  v_mfma_f32_16x16x32_bf16 v[16:19], a[156:159], v[68:71], v[16:19]
  v_mfma_f32_16x16x32_bf16 v[20:23], a[184:187], v[64:67], v[20:23]
  v_mfma_f32_16x16x32_bf16 v[20:23], a[188:191], v[68:71], v[20:23]
  v_max3_f32 v115, v0, v1, v2
  v_max3_f32 v115, v115, v3, v4
  v_max3_f32 v115, v115, v5, v6
  s_add_u32 m0, s34, 2048
  s_mov_b32 s31, 16384
  buffer_load_dwordx4 v119, s[16:19], s31 offen offset:0 nt lds
  v_max3_f32 v115, v115, v7, v8
  v_max3_f32 v115, v115, v9, v10
  v_max3_f32 v115, v115, v11, v12
  s_add_u32 m0, s34, 3072
  s_mov_b32 s31, 20480
  buffer_load_dwordx4 v119, s[16:19], s31 offen offset:0 nt lds
  v_max3_f32 v115, v115, v13, v14
  v_max3_f32 v115, v115, v15, v16
  v_max3_f32 v115, v115, v17, v18
  s_add_u32 m0, s34, 4096
  s_mov_b32 s31, 24576
  buffer_load_dwordx4 v119, s[16:19], s31 offen offset:0 nt lds
  v_max3_f32 v115, v115, v19, v20
  v_max3_f32 v115, v115, v21, v22
  v_max_f32 v115, v115, v23
  s_add_u32 m0, s34, 5120
  s_mov_b32 s31, 28672
  buffer_load_dwordx4 v119, s[16:19], s31 offen offset:0 nt lds
  ds_write_b32 v112, v115 offset:0
  ds_max_f32 v112, v115 offset:0
  s_waitcnt vmcnt(10) lgkmcnt(0)
  s_barrier
  ds_read_b128 v[64:67], v108 offset:8448
  ds_read_b128 v[68:71], v108 offset:8512
  ds_read_b128 v[72:75], v108 offset:8576
  ds_read_b128 v[76:79], v108 offset:8640
  s_waitcnt lgkmcnt(0)
  v_mfma_f32_16x16x32_bf16 v[24:27], a[0:3], v[64:67], 0
  ds_read_b128 v[104:107], v111 offset:0
  v_mfma_f32_16x16x32_bf16 v[24:27], a[4:7], v[68:71], v[24:27]
  s_add_u32 m0, s34, 6144
  s_mov_b32 s31, 32768
  buffer_load_dwordx4 v119, s[16:19], s31 offen offset:0 nt lds
  v_mfma_f32_16x16x32_bf16 v[24:27], a[8:11], v[72:75], v[24:27]
  ds_read_b128 v[80:83], v108 offset:8704
  ds_read_b128 v[84:87], v108 offset:8768
  ds_read_b128 v[88:91], v108 offset:8832
  v_mfma_f32_16x16x32_bf16 v[24:27], a[12:15], v[76:79], v[24:27]
  ds_read_b128 v[92:95], v108 offset:8896
  v_mfma_f32_16x16x32_bf16 v[28:31], a[32:35], v[64:67], 0
  v_mfma_f32_16x16x32_bf16 v[28:31], a[36:39], v[68:71], v[28:31]
  s_add_u32 m0, s34, 7168
  s_mov_b32 s31, 36864
  buffer_load_dwordx4 v119, s[16:19], s31 offen offset:0 nt lds
  v_mfma_f32_16x16x32_bf16 v[28:31], a[40:43], v[72:75], v[28:31]
  s_waitcnt lgkmcnt(4)
  v_max3_f32 v116, v104, v105, v106
  v_max_f32 v116, v116, v107
  v_mul_f32 v116, s24, v116
  v_mfma_f32_16x16x32_bf16 v[28:31], a[44:47], v[76:79], v[28:31]
  v_fma_f32 v0, v0, s24, -v116
  v_fma_f32 v1, v1, s24, -v116
  v_mfma_f32_16x16x32_bf16 v[32:35], a[64:67], v[64:67], 0
  v_exp_f32 v0, v0
  v_fma_f32 v2, v2, s24, -v116
  v_mfma_f32_16x16x32_bf16 v[32:35], a[68:71], v[68:71], v[32:35]
  s_add_u32 m0, s34, 8192
  s_mov_b32 s31, 40960
  buffer_load_dwordx4 v119, s[16:19], s31 offen offset:0 nt lds
  v_mfma_f32_16x16x32_bf16 v[32:35], a[72:75], v[72:75], v[32:35]
  v_fma_f32 v3, v3, s24, -v116
  v_exp_f32 v1, v1
  v_mfma_f32_16x16x32_bf16 v[32:35], a[76:79], v[76:79], v[32:35]
  v_exp_f32 v2, v2
  v_fma_f32 v4, v4, s24, -v116
  v_mfma_f32_16x16x32_bf16 v[36:39], a[96:99], v[64:67], 0
  v_cvt_pk_bf16_f32 v0, v0, v1
  v_exp_f32 v3, v3
  v_mfma_f32_16x16x32_bf16 v[36:39], a[100:103], v[68:71], v[36:39]
  s_add_u32 m0, s34, 9216
  s_mov_b32 s31, 45056
  buffer_load_dwordx4 v119, s[16:19], s31 offen offset:0 nt lds
  v_mfma_f32_16x16x32_bf16 v[36:39], a[104:107], v[72:75], v[36:39]
  v_fma_f32 v5, v5, s24, -v116
  v_fma_f32 v6, v6, s24, -v116
  s_add_u32 s33, s28, 16896
  v_exp_f32 v4, v4
  v_mfma_f32_16x16x32_bf16 v[36:39], a[108:111], v[76:79], v[36:39]
  v_fma_f32 v7, v7, s24, -v116
  v_cvt_pk_bf16_f32 v1, v2, v3
  v_mfma_f32_16x16x32_bf16 v[40:43], a[128:131], v[64:67], 0
  v_exp_f32 v5, v5
  v_exp_f32 v6, v6
  v_mfma_f32_16x16x32_bf16 v[40:43], a[132:135], v[68:71], v[40:43]
  v_exp_f32 v7, v7
  v_cvt_pk_bf16_f32 v2, v4, v5
  v_mfma_f32_16x16x32_bf16 v[40:43], a[136:139], v[72:75], v[40:43]
  s_waitcnt vmcnt(10)
  ds_read_b64_tr_b16 a[192:193], v120 offset:12288
  ds_read_b64_tr_b16 a[196:197], v120 offset:12296
  ds_read_b64_tr_b16 a[200:201], v121 offset:12288
  ds_read_b64_tr_b16 a[204:205], v121 offset:12296
  v_cvt_pk_bf16_f32 v3, v6, v7
  v_fma_f32 v8, v8, s24, -v116
  v_mfma_f32_16x16x32_bf16 v[40:43], a[140:143], v[76:79], v[40:43]
  v_fma_f32 v9, v9, s24, -v116
  v_exp_f32 v8, v8
  v_mfma_f32_16x16x32_bf16 v[44:47], a[160:163], v[64:67], 0
  v_fma_f32 v10, v10, s24, -v116
  s_cmp_eq_u32 s33, 67584
  s_cselect_b32 s33, 0, s33
  ds_write_b128 v110, v[0:3] offset:16896
  v_mfma_f32_16x16x32_bf16 v[44:47], a[164:167], v[68:71], v[44:47]
  v_fma_f32 v11, v11, s24, -v116
  v_exp_f32 v9, v9
  v_mfma_f32_16x16x32_bf16 v[100:103], v[96:99], v[0:3], 0
  v_exp_f32 v10, v10
  v_fma_f32 v12, v12, s24, -v116
  v_mfma_f32_16x16x32_bf16 v[44:47], a[168:171], v[72:75], v[44:47]
  v_cvt_pk_bf16_f32 v8, v8, v9
  v_exp_f32 v11, v11
  v_mfma_f32_16x16x32_bf16 v[44:47], a[172:175], v[76:79], v[44:47]
  s_waitcnt lgkmcnt(1)
  s_add_u32 m0, s34, 10240
  s_mov_b32 s31, 49152
  buffer_load_dwordx4 v119, s[16:19], s31 offen offset:0 nt lds
  v_mfma_f32_16x16x32_bf16 v[24:27], a[16:19], v[80:83], v[24:27]
  v_fma_f32 v13, v13, s24, -v116
  v_fma_f32 v14, v14, s24, -v116
  s_sub_u32 s37, s33, s28
  v_mfma_f32_16x16x32_bf16 v[24:27], a[20:23], v[84:87], v[24:27]
  v_exp_f32 v12, v12
  s_add_u32 s35, s29, s28
  v_mfma_f32_16x16x32_bf16 v[24:27], a[24:27], v[88:91], v[24:27]
  s_mov_b32 s28, s33
  v_fma_f32 v15, v15, s24, -v116
  v_add_u32 v108, s37, v108
  s_add_u32 m0, s34, 11264
  s_mov_b32 s31, 53248
  buffer_load_dwordx4 v119, s[16:19], s31 offen offset:0 nt lds
  v_mfma_f32_16x16x32_bf16 v[24:27], a[28:31], v[92:95], v[24:27]
  v_cvt_pk_bf16_f32 v9, v10, v11
  v_exp_f32 v13, v13
  v_mfma_f32_16x16x32_bf16 v[28:31], a[48:51], v[80:83], v[28:31]
  v_exp_f32 v14, v14
  v_exp_f32 v15, v15
  v_mfma_f32_16x16x32_bf16 v[28:31], a[52:55], v[84:87], v[28:31]
  v_cvt_pk_bf16_f32 v10, v12, v13
  v_cvt_pk_bf16_f32 v11, v14, v15
  v_fma_f32 v16, v16, s24, -v116
  v_mfma_f32_16x16x32_bf16 v[28:31], a[56:59], v[88:91], v[28:31]
  s_waitcnt vmcnt(10)
  ds_read_b64_tr_b16 a[194:195], v120 offset:0
  ds_read_b64_tr_b16 a[198:199], v120 offset:8
  ds_read_b64_tr_b16 a[202:203], v121 offset:0
  ds_read_b64_tr_b16 a[206:207], v121 offset:8
  v_fma_f32 v17, v17, s24, -v116
  v_exp_f32 v16, v16
  v_mfma_f32_16x16x32_bf16 v[28:31], a[60:63], v[92:95], v[28:31]
  v_fma_f32 v18, v18, s24, -v116
  v_max3_f32 v115, v24, v25, v26
  ds_write_b128 v110, v[8:11] offset:17920
  v_mfma_f32_16x16x32_bf16 v[32:35], a[80:83], v[80:83], v[32:35]
  v_fma_f32 v19, v19, s24, -v116
  v_exp_f32 v17, v17
  v_mfma_f32_16x16x32_bf16 v[100:103], v[96:99], v[8:11], v[100:103]
  v_exp_f32 v18, v18
  v_fma_f32 v20, v20, s24, -v116
  v_mfma_f32_16x16x32_bf16 v[32:35], a[84:87], v[84:87], v[32:35]
  v_cvt_pk_bf16_f32 v16, v16, v17
  v_exp_f32 v19, v19
  v_mfma_f32_16x16x32_bf16 v[32:35], a[88:91], v[88:91], v[32:35]
  v_fma_f32 v21, v21, s24, -v116
  v_fma_f32 v22, v22, s24, -v116
  v_mfma_f32_16x16x32_bf16 v[32:35], a[92:95], v[92:95], v[32:35]
  s_waitcnt lgkmcnt(1)
  s_add_u32 m0, s34, 12288
  s_mov_b32 s31, 57344
  buffer_load_dwordx4 v119, s[16:19], s31 offen offset:0 nt lds
  v_mfma_f32_16x16x32_bf16 v[36:39], a[112:115], v[80:83], v[36:39]
  v_exp_f32 v20, v20
  v_fma_f32 v23, v23, s24, -v116
  v_mfma_f32_16x16x32_bf16 v[36:39], a[116:119], v[84:87], v[36:39]
  v_cvt_pk_bf16_f32 v17, v18, v19
  v_exp_f32 v21, v21
  v_mfma_f32_16x16x32_bf16 v[36:39], a[120:123], v[88:91], v[36:39]
  s_add_u32 m0, s34, 13312
  s_mov_b32 s31, 61440
  buffer_load_dwordx4 v119, s[16:19], s31 offen offset:0 nt lds
  v_mfma_f32_16x16x32_bf16 v[36:39], a[124:127], v[92:95], v[36:39]
  v_exp_f32 v22, v22
  v_max3_f32 v115, v115, v27, v28
  v_mfma_f32_16x16x32_bf16 v[40:43], a[144:147], v[80:83], v[40:43]
  v_exp_f32 v23, v23
  v_cvt_pk_bf16_f32 v18, v20, v21
  s_add_u32 m0, s29, 59136
  s_mov_b32 s31, 24576
  buffer_load_dwordx4 v113, s[8:11], s31 offen offset:0 nt lds
  v_mfma_f32_16x16x32_bf16 v[40:43], a[148:151], v[84:87], v[40:43]
  v_cvt_pk_bf16_f32 v19, v22, v23
  v_max3_f32 v115, v115, v29, v30
  v_max3_f32 v115, v115, v31, v32
  v_mfma_f32_16x16x32_bf16 v[40:43], a[152:155], v[88:91], v[40:43]
  v_max3_f32 v115, v115, v33, v34
  v_mfma_f32_16x16x32_bf16 v[40:43], a[156:159], v[92:95], v[40:43]
  v_mfma_f32_16x16x32_bf16 v[100:103], v[96:99], v[16:19], v[100:103]
  ds_write_b128 v110, v[16:19] offset:18944
  v_mfma_f32_16x16x32_bf16 v[44:47], a[176:179], v[80:83], v[44:47]
  s_add_u32 m0, s29, 59168
  s_mov_b32 s31, 24576
  buffer_load_dwordx4 v113, s[8:11], s31 offen offset:1024 nt lds
  v_mfma_f32_16x16x32_bf16 v[44:47], a[180:183], v[84:87], v[44:47]
  v_max3_f32 v115, v115, v35, v36
  v_max3_f32 v115, v115, v37, v38
  v_mfma_f32_16x16x32_bf16 v[44:47], a[184:187], v[88:91], v[44:47]
  v_mfma_f32_16x16x32_bf16 v[44:47], a[188:191], v[92:95], v[44:47]
  ds_write_b32 v112, v100 offset:512
  v_max3_f32 v115, v115, v39, v40
  v_max3_f32 v115, v115, v41, v42
  s_nop 4
  v_max3_f32 v115, v115, v43, v44
  v_max3_f32 v115, v115, v45, v46
  v_max_f32 v115, v115, v47
  ds_write_b32 v112, v115 offset:256
  ds_max_f32 v112, v115 offset:256
  s_waitcnt lgkmcnt(0)
  s_barrier
  ds_read_b128 v[80:83], v108 offset:0
  ds_read_b128 v[84:87], v108 offset:64
  ds_read_b128 v[88:91], v108 offset:128
  ds_read_b128 v[92:95], v108 offset:192
  s_waitcnt lgkmcnt(0)
  v_mfma_f32_16x16x32_bf16 v[0:3], a[0:3], v[80:83], 0
  ds_read_b128 v[104:107], v111 offset:256
  ds_read_b128 v[100:103], v111 offset:512
  v_mfma_f32_16x16x32_bf16 v[0:3], a[4:7], v[84:87], v[0:3]
  ds_read_b128 v[64:67], v108 offset:256
  ds_read_b128 v[68:71], v108 offset:320
  ds_read_b128 v[72:75], v108 offset:384
  v_mfma_f32_16x16x32_bf16 v[0:3], a[8:11], v[88:91], v[0:3]
  s_waitcnt vmcnt(12)
  ds_read_b64_tr_b16 a[208:209], v120 offset:2048
  ds_read_b64_tr_b16 a[212:213], v120 offset:2056
  ds_read_b64_tr_b16 a[216:217], v121 offset:2048
  ds_read_b64_tr_b16 a[220:221], v121 offset:2056
  v_mfma_f32_16x16x32_bf16 v[0:3], a[12:15], v[92:95], v[0:3]
  ds_read_b128 v[76:79], v108 offset:448
  v_mfma_f32_16x16x32_bf16 v[4:7], a[32:35], v[80:83], 0
  v_mfma_f32_16x16x32_bf16 v[4:7], a[36:39], v[84:87], v[4:7]
  s_waitcnt lgkmcnt(9)
  v_max3_f32 v116, v104, v105, v106
  v_max_f32 v116, v116, v107
  v_mul_f32 v116, s24, v116
  v_mfma_f32_16x16x32_bf16 v[4:7], a[40:43], v[88:91], v[4:7]
  s_waitcnt lgkmcnt(8)
  v_add_f32 v100, v100, v101
  v_add_f32 v102, v102, v103
  v_add_f32 v117, v100, v102
  v_mfma_f32_16x16x32_bf16 v[4:7], a[44:47], v[92:95], v[4:7]
  s_waitcnt lgkmcnt(1)
  s_add_u32 m0, s34, 0
  s_mov_b32 s31, 65536
  buffer_load_dwordx4 v119, s[16:19], s31 offen offset:0 nt lds
  v_mfma_f32_16x16x32_bf16 v[8:11], a[64:67], v[80:83], 0
  v_fma_f32 v24, v24, s24, -v116
  v_fma_f32 v25, v25, s24, -v116
  v_mfma_f32_16x16x32_bf16 v[8:11], a[68:71], v[84:87], v[8:11]
  v_exp_f32 v24, v24
  v_fma_f32 v26, v26, s24, -v116
  v_mfma_f32_16x16x32_bf16 v[8:11], a[72:75], v[88:91], v[8:11]
  s_add_u32 m0, s34, 1024
  s_mov_b32 s31, 69632
  buffer_load_dwordx4 v119, s[16:19], s31 offen offset:0 nt lds
  v_mfma_f32_16x16x32_bf16 v[8:11], a[76:79], v[92:95], v[8:11]
  v_fma_f32 v27, v27, s24, -v116
  v_exp_f32 v25, v25
  v_mfma_f32_16x16x32_bf16 v[12:15], a[96:99], v[80:83], 0
  v_exp_f32 v26, v26
  v_fma_f32 v28, v28, s24, -v116
  v_mfma_f32_16x16x32_bf16 v[12:15], a[100:103], v[84:87], v[12:15]
  v_cvt_pk_bf16_f32 v24, v24, v25
  v_exp_f32 v27, v27
  v_mfma_f32_16x16x32_bf16 v[12:15], a[104:107], v[88:91], v[12:15]
  v_fma_f32 v29, v29, s24, -v116
  v_fma_f32 v30, v30, s24, -v116
  v_exp_f32 v28, v28
  v_mfma_f32_16x16x32_bf16 v[12:15], a[108:111], v[92:95], v[12:15]
  v_fma_f32 v31, v31, s24, -v116
  v_cvt_pk_bf16_f32 v25, v26, v27
  v_mfma_f32_16x16x32_bf16 v[16:19], a[128:131], v[80:83], 0
  s_waitcnt vmcnt(12)
  ds_read_b64_tr_b16 a[210:211], v120 offset:4096
  ds_read_b64_tr_b16 a[214:215], v120 offset:4104
  ds_read_b64_tr_b16 a[218:219], v121 offset:4096
  ds_read_b64_tr_b16 a[222:223], v121 offset:4104
  v_exp_f32 v29, v29
  v_exp_f32 v30, v30
  v_mfma_f32_16x16x32_bf16 v[16:19], a[132:135], v[84:87], v[16:19]
  v_exp_f32 v31, v31
  v_cvt_pk_bf16_f32 v26, v28, v29
  v_mfma_f32_16x16x32_bf16 v[16:19], a[136:139], v[88:91], v[16:19]
  v_cvt_pk_bf16_f32 v27, v30, v31
  v_fma_f32 v32, v32, s24, -v116
  v_fma_f32 v33, v33, s24, -v116
  v_mfma_f32_16x16x32_bf16 v[16:19], a[140:143], v[92:95], v[16:19]
  v_exp_f32 v32, v32
  v_fma_f32 v34, v34, s24, -v116
  v_mfma_f32_16x16x32_bf16 v[20:23], a[160:163], v[80:83], 0
  ds_write_b128 v110, v[24:27] offset:29184
  v_mfma_f32_16x16x32_bf16 v[20:23], a[164:167], v[84:87], v[20:23]
  v_fma_f32 v35, v35, s24, -v116
  s_waitcnt lgkmcnt(1)
  s_add_u32 m0, s34, 2048
  s_mov_b32 s31, 73728
  buffer_load_dwordx4 v119, s[16:19], s31 offen offset:0 nt lds
  v_mfma_f32_16x16x32_bf16 v[20:23], a[168:171], v[88:91], v[20:23]
  v_exp_f32 v33, v33
  v_mfma_f32_16x16x32_bf16 v[100:103], v[96:99], v[24:27], 0
  v_exp_f32 v34, v34
  v_fma_f32 v36, v36, s24, -v116
  v_mfma_f32_16x16x32_bf16 v[20:23], a[172:175], v[92:95], v[20:23]
  v_cvt_pk_bf16_f32 v32, v32, v33
  v_exp_f32 v35, v35
  v_mfma_f32_16x16x32_bf16 v[0:3], a[16:19], v[64:67], v[0:3]
  s_add_u32 m0, s34, 3072
  s_mov_b32 s31, 77824
  buffer_load_dwordx4 v119, s[16:19], s31 offen offset:0 nt lds
  v_mfma_f32_16x16x32_bf16 v[0:3], a[20:23], v[68:71], v[0:3]
  v_fma_f32 v37, v37, s24, -v116
  v_fma_f32 v38, v38, s24, -v116
  v_mfma_f32_16x16x32_bf16 v[0:3], a[24:27], v[72:75], v[0:3]
  v_exp_f32 v36, v36
  v_fma_f32 v39, v39, s24, -v116
  v_mfma_f32_16x16x32_bf16 v[0:3], a[28:31], v[76:79], v[0:3]
  v_cvt_pk_bf16_f32 v33, v34, v35
  v_exp_f32 v37, v37
  v_mfma_f32_16x16x32_bf16 v[4:7], a[48:51], v[64:67], v[4:7]
  v_exp_f32 v38, v38
  v_exp_f32 v39, v39
  v_mfma_f32_16x16x32_bf16 v[4:7], a[52:55], v[68:71], v[4:7]
  v_cvt_pk_bf16_f32 v34, v36, v37
  v_cvt_pk_bf16_f32 v35, v38, v39
  v_fma_f32 v40, v40, s24, -v116
  v_mfma_f32_16x16x32_bf16 v[4:7], a[56:59], v[72:75], v[4:7]
  s_waitcnt vmcnt(12)
  ds_read_b64_tr_b16 a[224:225], v120 offset:6144
  ds_read_b64_tr_b16 a[228:229], v120 offset:6152
  ds_read_b64_tr_b16 a[232:233], v121 offset:6144
  ds_read_b64_tr_b16 a[236:237], v121 offset:6152
  v_fma_f32 v41, v41, s24, -v116
  v_exp_f32 v40, v40
  v_mfma_f32_16x16x32_bf16 v[4:7], a[60:63], v[76:79], v[4:7]
  v_fma_f32 v42, v42, s24, -v116
  v_rcp_f32 v122, v117
  ds_write_b128 v110, v[32:35] offset:30208
  v_mfma_f32_16x16x32_bf16 v[8:11], a[80:83], v[64:67], v[8:11]
  v_fma_f32 v43, v43, s24, -v116
  v_exp_f32 v41, v41
  v_mfma_f32_16x16x32_bf16 v[100:103], v[96:99], v[32:35], v[100:103]
  v_exp_f32 v42, v42
  v_fma_f32 v44, v44, s24, -v116
  v_mfma_f32_16x16x32_bf16 v[8:11], a[84:87], v[68:71], v[8:11]
  v_cvt_pk_bf16_f32 v40, v40, v41
  v_exp_f32 v43, v43
  v_mfma_f32_16x16x32_bf16 v[8:11], a[88:91], v[72:75], v[8:11]
  v_fma_f32 v45, v45, s24, -v116
  v_fma_f32 v46, v46, s24, -v116
  v_max3_f32 v115, v0, v1, v2
  v_mfma_f32_16x16x32_bf16 v[8:11], a[92:95], v[76:79], v[8:11]
  s_waitcnt lgkmcnt(1)
  s_add_u32 m0, s34, 4096
  s_mov_b32 s31, 81920
  buffer_load_dwordx4 v119, s[16:19], s31 offen offset:0 nt lds
  v_mfma_f32_16x16x32_bf16 v[12:15], a[112:115], v[64:67], v[12:15]
  v_exp_f32 v44, v44
  v_fma_f32 v47, v47, s24, -v116
  v_mfma_f32_16x16x32_bf16 v[12:15], a[116:119], v[68:71], v[12:15]
  v_cvt_pk_bf16_f32 v41, v42, v43
  v_exp_f32 v45, v45
  v_mfma_f32_16x16x32_bf16 v[12:15], a[120:123], v[72:75], v[12:15]
  s_add_u32 m0, s34, 5120
  s_mov_b32 s31, 86016
  buffer_load_dwordx4 v119, s[16:19], s31 offen offset:0 nt lds
  v_mfma_f32_16x16x32_bf16 v[12:15], a[124:127], v[76:79], v[12:15]
  v_exp_f32 v46, v46
  v_max3_f32 v115, v115, v3, v4
  v_mfma_f32_16x16x32_bf16 v[16:19], a[144:147], v[64:67], v[16:19]
  v_exp_f32 v47, v47
  v_cvt_pk_bf16_f32 v42, v44, v45
  v_mfma_f32_16x16x32_bf16 v[16:19], a[148:151], v[68:71], v[16:19]
  v_cvt_pk_bf16_f32 v43, v46, v47
  v_max3_f32 v115, v115, v5, v6
  v_max3_f32 v115, v115, v7, v8
  v_mfma_f32_16x16x32_bf16 v[16:19], a[152:155], v[72:75], v[16:19]
  v_max3_f32 v115, v115, v9, v10
  v_mfma_f32_16x16x32_bf16 v[16:19], a[156:159], v[76:79], v[16:19]
  v_mfma_f32_16x16x32_bf16 v[100:103], v[96:99], v[40:43], v[100:103]
  ds_write_b128 v110, v[40:43] offset:31232
  v_mfma_f32_16x16x32_bf16 v[20:23], a[176:179], v[64:67], v[20:23]
  v_max3_f32 v115, v115, v11, v12
  v_max3_f32 v115, v115, v13, v14
  v_mfma_f32_16x16x32_bf16 v[20:23], a[180:183], v[68:71], v[20:23]
  v_mfma_f32_16x16x32_bf16 v[20:23], a[184:187], v[72:75], v[20:23]
  v_mfma_f32_16x16x32_bf16 v[20:23], a[188:191], v[76:79], v[20:23]
  s_nop 0
  ds_write_b32 v112, v100 offset:768
  v_max3_f32 v115, v115, v15, v16
  v_max3_f32 v115, v115, v17, v18
  s_nop 3
  v_max3_f32 v115, v115, v19, v20
  v_max3_f32 v115, v115, v21, v22
  v_max_f32 v115, v115, v23
  ds_write_b32 v112, v115 offset:0
  ds_max_f32 v112, v115 offset:0
  s_waitcnt vmcnt(6) lgkmcnt(0)
  s_barrier
  ds_read_b128 v[64:67], v108 offset:8448
  ds_read_b128 v[68:71], v108 offset:8512
  ds_read_b128 v[72:75], v108 offset:8576
  ds_read_b128 v[76:79], v108 offset:8640
  s_waitcnt lgkmcnt(0)
  v_mfma_f32_16x16x32_bf16 v[24:27], a[0:3], v[64:67], 0
  ds_read_b128 v[104:107], v111 offset:0
  ds_read_b128 v[100:103], v111 offset:768
  v_mfma_f32_16x16x32_bf16 v[24:27], a[4:7], v[68:71], v[24:27]
  ds_read_b128 v[80:83], v108 offset:8704
  ds_read_b128 v[84:87], v108 offset:8768
  ds_read_b128 v[88:91], v108 offset:8832
  v_mfma_f32_16x16x32_bf16 v[24:27], a[8:11], v[72:75], v[24:27]
  ds_read_b64_tr_b16 a[226:227], v120 offset:8192
  ds_read_b64_tr_b16 a[230:231], v120 offset:8200
  ds_read_b64_tr_b16 a[234:235], v121 offset:8192
  ds_read_b64_tr_b16 a[238:239], v121 offset:8200
  v_mfma_f32_16x16x32_bf16 v[24:27], a[12:15], v[76:79], v[24:27]
  ds_read_b128 v[92:95], v108 offset:8896
  v_mfma_f32_16x16x32_bf16 v[28:31], a[32:35], v[64:67], 0
  v_mfma_f32_16x16x32_bf16 v[28:31], a[36:39], v[68:71], v[28:31]
  s_waitcnt lgkmcnt(9)
  v_max3_f32 v116, v104, v105, v106
  v_max_f32 v116, v116, v107
  v_mul_f32 v116, s24, v116
  v_mfma_f32_16x16x32_bf16 v[28:31], a[40:43], v[72:75], v[28:31]
  s_waitcnt lgkmcnt(8)
  v_add_f32 v100, v100, v101
  v_add_f32 v102, v102, v103
  v_add_f32 v117, v100, v102
  v_mfma_f32_16x16x32_bf16 v[28:31], a[44:47], v[76:79], v[28:31]
  s_waitcnt lgkmcnt(1)
  s_add_u32 m0, s34, 6144
  s_mov_b32 s31, 90112
  buffer_load_dwordx4 v119, s[16:19], s31 offen offset:0 nt lds
  v_mfma_f32_16x16x32_bf16 v[32:35], a[64:67], v[64:67], 0
  v_fma_f32 v0, v0, s24, -v116
  v_fma_f32 v1, v1, s24, -v116
  v_mfma_f32_16x16x32_bf16 v[32:35], a[68:71], v[68:71], v[32:35]
  v_exp_f32 v0, v0
  v_fma_f32 v2, v2, s24, -v116
  v_mfma_f32_16x16x32_bf16 v[32:35], a[72:75], v[72:75], v[32:35]
  s_add_u32 m0, s34, 7168
  s_mov_b32 s31, 94208
  buffer_load_dwordx4 v119, s[16:19], s31 offen offset:0 nt lds
  v_mfma_f32_16x16x32_bf16 v[32:35], a[76:79], v[76:79], v[32:35]
  v_fma_f32 v3, v3, s24, -v116
  v_exp_f32 v1, v1
  v_mfma_f32_16x16x32_bf16 v[36:39], a[96:99], v[64:67], 0
  v_exp_f32 v2, v2
  v_fma_f32 v4, v4, s24, -v116
  v_mfma_f32_16x16x32_bf16 v[36:39], a[100:103], v[68:71], v[36:39]
  v_cvt_pk_bf16_f32 v0, v0, v1
  v_exp_f32 v3, v3
  v_mfma_f32_16x16x32_bf16 v[36:39], a[104:107], v[72:75], v[36:39]
  ds_read_b64_tr_b16 a[240:241], v120 offset:10240
  ds_read_b64_tr_b16 a[244:245], v120 offset:10248
  ds_read_b64_tr_b16 a[248:249], v121 offset:10240
  ds_read_b64_tr_b16 a[252:253], v121 offset:10248
  v_fma_f32 v5, v5, s24, -v116
  v_fma_f32 v6, v6, s24, -v116
  v_exp_f32 v4, v4
  v_mfma_f32_16x16x32_bf16 v[36:39], a[108:111], v[76:79], v[36:39]
  v_fma_f32 v7, v7, s24, -v116
  v_cvt_pk_bf16_f32 v1, v2, v3
  s_add_u32 s33, s28, 16896
  v_mfma_f32_16x16x32_bf16 v[40:43], a[128:131], v[64:67], 0
  v_exp_f32 v5, v5
  v_exp_f32 v6, v6
  v_mfma_f32_16x16x32_bf16 v[40:43], a[132:135], v[68:71], v[40:43]
  v_exp_f32 v7, v7
  v_cvt_pk_bf16_f32 v2, v4, v5
  v_mfma_f32_16x16x32_bf16 v[40:43], a[136:139], v[72:75], v[40:43]
  v_cvt_pk_bf16_f32 v3, v6, v7
  v_fma_f32 v8, v8, s24, -v116
  v_fma_f32 v9, v9, s24, -v116
  v_mfma_f32_16x16x32_bf16 v[40:43], a[140:143], v[76:79], v[40:43]
  v_exp_f32 v8, v8
  s_waitcnt lgkmcnt(0)
  s_add_u32 m0, s34, 8192
  s_mov_b32 s31, 98304
  buffer_load_dwordx4 v119, s[16:19], s31 offen offset:0 nt lds
  v_mfma_f32_16x16x32_bf16 v[44:47], a[160:163], v[64:67], 0
  v_fma_f32 v10, v10, s24, -v116
  s_cmp_eq_u32 s33, 67584
  s_cselect_b32 s33, 0, s33
  ds_write_b128 v110, v[0:3] offset:41472
  v_mfma_f32_16x16x32_bf16 v[44:47], a[164:167], v[68:71], v[44:47]
  v_fma_f32 v11, v11, s24, -v116
  v_exp_f32 v9, v9
  v_mfma_f32_16x16x32_bf16 v[100:103], v[96:99], v[0:3], 0
  v_exp_f32 v10, v10
  v_fma_f32 v12, v12, s24, -v116
  v_mfma_f32_16x16x32_bf16 v[44:47], a[168:171], v[72:75], v[44:47]
  s_add_u32 m0, s34, 9216
  s_mov_b32 s31, 102400
  buffer_load_dwordx4 v119, s[16:19], s31 offen offset:0 nt lds
  v_mfma_f32_16x16x32_bf16 v[44:47], a[172:175], v[76:79], v[44:47]
  v_cvt_pk_bf16_f32 v8, v8, v9
  v_exp_f32 v11, v11
  v_mfma_f32_16x16x32_bf16 v[24:27], a[16:19], v[80:83], v[24:27]
  v_fma_f32 v13, v13, s24, -v116
  v_fma_f32 v14, v14, s24, -v116
  s_sub_u32 s37, s33, s28
  v_mfma_f32_16x16x32_bf16 v[24:27], a[20:23], v[84:87], v[24:27]
  v_exp_f32 v12, v12
  s_add_u32 s35, s29, s28
  v_mfma_f32_16x16x32_bf16 v[24:27], a[24:27], v[88:91], v[24:27]
  ds_read_b64_tr_b16 a[242:243], v120 offset:12288
  ds_read_b64_tr_b16 a[246:247], v120 offset:12296
  ds_read_b64_tr_b16 a[250:251], v121 offset:12288
  ds_read_b64_tr_b16 a[254:255], v121 offset:12296
  s_mov_b32 s28, s33
  v_fma_f32 v15, v15, s24, -v116
  v_add_u32 v108, s37, v108
  v_mfma_f32_16x16x32_bf16 v[24:27], a[28:31], v[92:95], v[24:27]
  v_cvt_pk_bf16_f32 v9, v10, v11
  v_exp_f32 v13, v13
  v_mfma_f32_16x16x32_bf16 v[28:31], a[48:51], v[80:83], v[28:31]
  v_exp_f32 v14, v14
  v_exp_f32 v15, v15
  v_mfma_f32_16x16x32_bf16 v[28:31], a[52:55], v[84:87], v[28:31]
  v_cvt_pk_bf16_f32 v10, v12, v13
  v_cvt_pk_bf16_f32 v11, v14, v15
  v_fma_f32 v16, v16, s24, -v116
  v_mfma_f32_16x16x32_bf16 v[28:31], a[56:59], v[88:91], v[28:31]
  v_fma_f32 v17, v17, s24, -v116
  v_exp_f32 v16, v16
  v_mfma_f32_16x16x32_bf16 v[28:31], a[60:63], v[92:95], v[28:31]
  v_fma_f32 v18, v18, s24, -v116
  ds_write_b128 v110, v[8:11] offset:42496
  s_waitcnt lgkmcnt(1)
  s_add_u32 m0, s34, 10240
  s_mov_b32 s31, 106496
  buffer_load_dwordx4 v119, s[16:19], s31 offen offset:0 nt lds
  v_mfma_f32_16x16x32_bf16 v[32:35], a[80:83], v[80:83], v[32:35]
  v_fma_f32 v19, v19, s24, -v116
  v_exp_f32 v17, v17
  v_mfma_f32_16x16x32_bf16 v[100:103], v[96:99], v[8:11], v[100:103]
  v_exp_f32 v18, v18
  v_fma_f32 v20, v20, s24, -v116
  v_mfma_f32_16x16x32_bf16 v[32:35], a[84:87], v[84:87], v[32:35]
  v_cvt_pk_bf16_f32 v16, v16, v17
  v_exp_f32 v19, v19
  v_mfma_f32_16x16x32_bf16 v[32:35], a[88:91], v[88:91], v[32:35]
  s_add_u32 m0, s34, 11264
  s_mov_b32 s31, 110592
  buffer_load_dwordx4 v119, s[16:19], s31 offen offset:0 nt lds
  v_mfma_f32_16x16x32_bf16 v[32:35], a[92:95], v[92:95], v[32:35]
  v_fma_f32 v21, v21, s24, -v116
  v_fma_f32 v22, v22, s24, -v116
  v_max3_f32 v115, v24, v25, v26
  v_mfma_f32_16x16x32_bf16 v[36:39], a[112:115], v[80:83], v[36:39]
  v_exp_f32 v20, v20
  v_fma_f32 v23, v23, s24, -v116
  v_mfma_f32_16x16x32_bf16 v[36:39], a[116:119], v[84:87], v[36:39]
  v_cvt_pk_bf16_f32 v17, v18, v19
  v_exp_f32 v21, v21
  v_mfma_f32_16x16x32_bf16 v[36:39], a[120:123], v[88:91], v[36:39]
  s_waitcnt vmcnt(10)
  ds_read_b64_tr_b16 v[128:129], v120 offset:0
  ds_read_b64_tr_b16 v[132:133], v120 offset:8
  ds_read_b64_tr_b16 v[136:137], v121 offset:0
  ds_read_b64_tr_b16 v[140:141], v121 offset:8
  v_mfma_f32_16x16x32_bf16 v[36:39], a[124:127], v[92:95], v[36:39]
  v_exp_f32 v22, v22
  v_max3_f32 v115, v115, v27, v28
  v_mfma_f32_16x16x32_bf16 v[40:43], a[144:147], v[80:83], v[40:43]
  v_exp_f32 v23, v23
  v_cvt_pk_bf16_f32 v18, v20, v21
  v_mfma_f32_16x16x32_bf16 v[40:43], a[148:151], v[84:87], v[40:43]
  v_cvt_pk_bf16_f32 v19, v22, v23
  v_rcp_f32 v123, v117
  v_mfma_f32_16x16x32_bf16 v[40:43], a[152:155], v[88:91], v[40:43]
  v_max3_f32 v115, v115, v29, v30
  v_max3_f32 v115, v115, v31, v32
  v_max3_f32 v115, v115, v33, v34
  v_mfma_f32_16x16x32_bf16 v[40:43], a[156:159], v[92:95], v[40:43]
  v_mfma_f32_16x16x32_bf16 v[100:103], v[96:99], v[16:19], v[100:103]
  ds_write_b128 v110, v[16:19] offset:43520
  s_waitcnt lgkmcnt(1)
  s_add_u32 m0, s34, 12288
  s_mov_b32 s31, 114688
  buffer_load_dwordx4 v119, s[16:19], s31 offen offset:0 nt lds
  v_mfma_f32_16x16x32_bf16 v[44:47], a[176:179], v[80:83], v[44:47]
  v_max3_f32 v115, v115, v35, v36
  v_max3_f32 v115, v115, v37, v38
  v_mfma_f32_16x16x32_bf16 v[44:47], a[180:183], v[84:87], v[44:47]
  v_mfma_f32_16x16x32_bf16 v[44:47], a[184:187], v[88:91], v[44:47]
  s_add_u32 m0, s34, 13312
  s_mov_b32 s31, 118784
  buffer_load_dwordx4 v119, s[16:19], s31 offen offset:0 nt lds
  v_mfma_f32_16x16x32_bf16 v[44:47], a[188:191], v[92:95], v[44:47]
  ds_write_b32 v112, v100 offset:512
  v_max3_f32 v115, v115, v39, v40
  v_max3_f32 v115, v115, v41, v42
  s_nop 4
  v_max3_f32 v115, v115, v43, v44
  v_max3_f32 v115, v115, v45, v46
  v_max_f32 v115, v115, v47
  ds_write_b32 v112, v115 offset:256
  ds_max_f32 v112, v115 offset:256
  s_waitcnt lgkmcnt(0)
  s_barrier
  s_mov_b32 s84, 0
  s_mov_b32 s85, 8192
  s_mov_b32 s86, 16384
  ds_read_b128 v[104:107], v111 offset:256
  ds_read_b128 v[100:103], v111 offset:512
  ds_read_b128 v[80:83], v109 offset:16896
  ds_read_b128 v[84:87], v109 offset:29184
  ds_read_b128 v[88:91], v109 offset:17920
  s_waitcnt lgkmcnt(4)
  v_max3_f32 v116, v104, v105, v106
  v_max_f32 v116, v116, v107
  v_mul_f32 v116, s24, v116
  s_waitcnt lgkmcnt(3)
  v_add_f32 v100, v100, v101
  v_add_f32 v102, v102, v103
  v_add_f32 v117, v100, v102
  v_rcp_f32 v124, v117
  s_waitcnt lgkmcnt(2)
  v_mfma_f32_16x16x32_bf16 v[0:3], a[192:195], v[80:83], 0
  ds_read_b128 v[92:95], v109 offset:30208
  s_waitcnt vmcnt(10)
  ds_read_b64_tr_b16 v[130:131], v120 offset:2048
  ds_read_b64_tr_b16 v[134:135], v120 offset:2056
  ds_read_b64_tr_b16 v[138:139], v121 offset:2048
  ds_read_b64_tr_b16 v[142:143], v121 offset:2056
  v_mfma_f32_16x16x32_bf16 v[4:7], a[196:199], v[80:83], 0
  v_fma_f32 v24, v24, s24, -v116
  v_fma_f32 v25, v25, s24, -v116
  v_exp_f32 v24, v24
  v_mfma_f32_16x16x32_bf16 v[8:11], a[200:203], v[80:83], 0
  v_fma_f32 v26, v26, s24, -v116
  v_fma_f32 v27, v27, s24, -v116
  v_exp_f32 v25, v25
  v_mfma_f32_16x16x32_bf16 v[12:15], a[204:207], v[80:83], 0
  v_exp_f32 v26, v26
  v_fma_f32 v28, v28, s24, -v116
  v_cvt_pk_bf16_f32 v24, v24, v25
  s_waitcnt lgkmcnt(6)
  v_mfma_f32_16x16x32_bf16 v[64:67], a[192:195], v[84:87], 0
  ds_read_b128 v[80:83], v109 offset:18944
  v_exp_f32 v27, v27
  v_fma_f32 v29, v29, s24, -v116
  v_mfma_f32_16x16x32_bf16 v[68:71], a[196:199], v[84:87], 0
  s_waitcnt lgkmcnt(1)
  s_add_u32 m0, s34, 0
  s_mov_b32 s31, 122880
  buffer_load_dwordx4 v119, s[16:19], s31 offen offset:0 nt lds
  v_mfma_f32_16x16x32_bf16 v[72:75], a[200:203], v[84:87], 0
  v_fma_f32 v30, v30, s24, -v116
  v_exp_f32 v28, v28
  v_fma_f32 v31, v31, s24, -v116
  v_mfma_f32_16x16x32_bf16 v[76:79], a[204:207], v[84:87], 0
  v_cvt_pk_bf16_f32 v25, v26, v27
  s_add_u32 m0, s34, 1024
  s_mov_b32 s31, 126976
  buffer_load_dwordx4 v119, s[16:19], s31 offen offset:0 nt lds
  v_mfma_f32_16x16x32_bf16 v[0:3], a[208:211], v[88:91], v[0:3]
  ds_read_b128 v[84:87], v109 offset:31232
  v_exp_f32 v29, v29
  v_exp_f32 v30, v30
  v_mfma_f32_16x16x32_bf16 v[4:7], a[212:215], v[88:91], v[4:7]
  v_exp_f32 v31, v31
  v_cvt_pk_bf16_f32 v26, v28, v29
  v_cvt_pk_bf16_f32 v27, v30, v31
  v_mfma_f32_16x16x32_bf16 v[8:11], a[216:219], v[88:91], v[8:11]
  v_fma_f32 v32, v32, s24, -v116
  v_fma_f32 v33, v33, s24, -v116
  v_exp_f32 v32, v32
  v_mfma_f32_16x16x32_bf16 v[12:15], a[220:223], v[88:91], v[12:15]
  s_waitcnt vmcnt(10)
  ds_read_b64_tr_b16 v[144:145], v120 offset:4096
  ds_read_b64_tr_b16 v[148:149], v120 offset:4104
  ds_read_b64_tr_b16 v[152:153], v121 offset:4096
  ds_read_b64_tr_b16 v[156:157], v121 offset:4104
  v_fma_f32 v34, v34, s24, -v116
  ds_write_b128 v110, v[24:27] offset:0
  v_mfma_f32_16x16x32_bf16 v[64:67], a[208:211], v[92:95], v[64:67]
  ds_read_b128 v[88:91], v109 offset:19968
  v_fma_f32 v35, v35, s24, -v116
  v_exp_f32 v33, v33
  v_mfma_f32_16x16x32_bf16 v[100:103], v[96:99], v[24:27], 0
  v_exp_f32 v34, v34
  v_fma_f32 v36, v36, s24, -v116
  v_cvt_pk_bf16_f32 v32, v32, v33
  v_mfma_f32_16x16x32_bf16 v[68:71], a[212:215], v[92:95], v[68:71]
  v_exp_f32 v35, v35
  v_fma_f32 v37, v37, s24, -v116
  v_fma_f32 v38, v38, s24, -v116
  v_mfma_f32_16x16x32_bf16 v[72:75], a[216:219], v[92:95], v[72:75]
  v_exp_f32 v36, v36
  v_fma_f32 v39, v39, s24, -v116
  v_cvt_pk_bf16_f32 v33, v34, v35
  v_mfma_f32_16x16x32_bf16 v[76:79], a[220:223], v[92:95], v[76:79]
  v_exp_f32 v37, v37
  v_exp_f32 v38, v38
  s_waitcnt lgkmcnt(7)
  v_mfma_f32_16x16x32_bf16 v[0:3], a[224:227], v[80:83], v[0:3]
  ds_read_b128 v[92:95], v109 offset:32256
  s_waitcnt lgkmcnt(3)
  s_add_u32 m0, s34, 2048
  s_mov_b32 s31, 131072
  buffer_load_dwordx4 v119, s[16:19], s31 offen offset:0 nt lds
  v_mfma_f32_16x16x32_bf16 v[4:7], a[228:231], v[80:83], v[4:7]
  v_exp_f32 v39, v39
  v_cvt_pk_bf16_f32 v34, v36, v37
  v_cvt_pk_bf16_f32 v35, v38, v39
  v_mfma_f32_16x16x32_bf16 v[8:11], a[232:235], v[80:83], v[8:11]
  v_fma_f32 v40, v40, s24, -v116
  v_fma_f32 v41, v41, s24, -v116
  s_add_u32 m0, s34, 3072
  s_mov_b32 s31, 135168
  buffer_load_dwordx4 v119, s[16:19], s31 offen offset:0 nt lds
  v_mfma_f32_16x16x32_bf16 v[12:15], a[236:239], v[80:83], v[12:15]
  v_exp_f32 v40, v40
  v_fma_f32 v42, v42, s24, -v116
  ds_write_b128 v110, v[32:35] offset:1024
  v_mfma_f32_16x16x32_bf16 v[64:67], a[224:227], v[84:87], v[64:67]
  ds_read_b128 v[80:83], v109 offset:41472
  v_fma_f32 v43, v43, s24, -v116
  v_exp_f32 v41, v41
  v_mfma_f32_16x16x32_bf16 v[100:103], v[96:99], v[32:35], v[100:103]
  v_exp_f32 v42, v42
  v_fma_f32 v44, v44, s24, -v116
  v_cvt_pk_bf16_f32 v40, v40, v41
  v_mfma_f32_16x16x32_bf16 v[68:71], a[228:231], v[84:87], v[68:71]
  v_exp_f32 v43, v43
  v_fma_f32 v45, v45, s24, -v116
  v_fma_f32 v46, v46, s24, -v116
  v_mfma_f32_16x16x32_bf16 v[72:75], a[232:235], v[84:87], v[72:75]
  v_exp_f32 v44, v44
  v_fma_f32 v47, v47, s24, -v116
  v_cvt_pk_bf16_f32 v41, v42, v43
  v_mfma_f32_16x16x32_bf16 v[76:79], a[236:239], v[84:87], v[76:79]
  s_waitcnt vmcnt(10)
  ds_read_b64_tr_b16 v[146:147], v120 offset:6144
  ds_read_b64_tr_b16 v[150:151], v120 offset:6152
  ds_read_b64_tr_b16 v[154:155], v121 offset:6144
  ds_read_b64_tr_b16 v[158:159], v121 offset:6152
  s_waitcnt lgkmcnt(7)
  v_mfma_f32_16x16x32_bf16 v[0:3], a[240:243], v[88:91], v[0:3]
  v_exp_f32 v45, v45
  v_exp_f32 v46, v46
  v_mfma_f32_16x16x32_bf16 v[4:7], a[244:247], v[88:91], v[4:7]
  v_exp_f32 v47, v47
  v_cvt_pk_bf16_f32 v42, v44, v45
  v_cvt_pk_bf16_f32 v43, v46, v47
  v_mfma_f32_16x16x32_bf16 v[8:11], a[248:251], v[88:91], v[8:11]
  v_mfma_f32_16x16x32_bf16 v[12:15], a[252:255], v[88:91], v[12:15]
  v_mfma_f32_16x16x32_bf16 v[100:103], v[96:99], v[40:43], v[100:103]
  ds_write_b128 v110, v[40:43] offset:2048
  s_waitcnt lgkmcnt(7)
  v_mfma_f32_16x16x32_bf16 v[64:67], a[240:243], v[92:95], v[64:67]
  ds_read_b128 v[88:91], v109 offset:42496
  s_waitcnt lgkmcnt(2)
  s_add_u32 m0, s34, 4096
  s_mov_b32 s31, 139264
  buffer_load_dwordx4 v119, s[16:19], s31 offen offset:0 nt lds
  v_mfma_f32_16x16x32_bf16 v[68:71], a[244:247], v[92:95], v[68:71]
  v_mfma_f32_16x16x32_bf16 v[72:75], a[248:251], v[92:95], v[72:75]
  s_add_u32 m0, s34, 5120
  s_mov_b32 s31, 143360
  buffer_load_dwordx4 v119, s[16:19], s31 offen offset:0 nt lds
  v_mfma_f32_16x16x32_bf16 v[76:79], a[252:255], v[92:95], v[76:79]
  s_waitcnt lgkmcnt(1)
  s_barrier
  ds_read_b128 v[84:87], v109 offset:0
  ds_write_b32 v112, v100 offset:768
  v_mfma_f32_16x16x32_bf16 v[24:27], a[192:195], v[80:83], 0
  ds_read_b128 v[92:95], v109 offset:1024
  v_mfma_f32_16x16x32_bf16 v[28:31], a[196:199], v[80:83], 0
  s_waitcnt vmcnt(10)
  ds_read_b64_tr_b16 v[160:161], v120 offset:8192
  ds_read_b64_tr_b16 v[164:165], v120 offset:8200
  ds_read_b64_tr_b16 v[168:169], v121 offset:8192
  ds_read_b64_tr_b16 v[172:173], v121 offset:8200
  v_mfma_f32_16x16x32_bf16 v[32:35], a[200:203], v[80:83], 0
  v_mfma_f32_16x16x32_bf16 v[36:39], a[204:207], v[80:83], 0
  s_waitcnt lgkmcnt(6)
  v_mfma_f32_16x16x32_bf16 v[48:51], a[192:195], v[84:87], 0
  ds_read_b128 v[80:83], v109 offset:43520
  v_mfma_f32_16x16x32_bf16 v[52:55], a[196:199], v[84:87], 0
  v_mfma_f32_16x16x32_bf16 v[56:59], a[200:203], v[84:87], 0
  s_waitcnt lgkmcnt(1)
  s_add_u32 m0, s34, 6144
  s_mov_b32 s31, 147456
  buffer_load_dwordx4 v119, s[16:19], s31 offen offset:0 nt lds
  v_mfma_f32_16x16x32_bf16 v[60:63], a[204:207], v[84:87], 0
  v_mfma_f32_16x16x32_bf16 v[24:27], a[208:211], v[88:91], v[24:27]
  ds_read_b128 v[84:87], v109 offset:2048
  s_add_u32 m0, s34, 7168
  s_mov_b32 s31, 151552
  buffer_load_dwordx4 v119, s[16:19], s31 offen offset:0 nt lds
  v_mfma_f32_16x16x32_bf16 v[28:31], a[212:215], v[88:91], v[28:31]
  v_mfma_f32_16x16x32_bf16 v[32:35], a[216:219], v[88:91], v[32:35]
  v_mfma_f32_16x16x32_bf16 v[36:39], a[220:223], v[88:91], v[36:39]
  v_mfma_f32_16x16x32_bf16 v[48:51], a[208:211], v[92:95], v[48:51]
  ds_read_b128 v[88:91], v109 offset:44544
  v_mfma_f32_16x16x32_bf16 v[52:55], a[212:215], v[92:95], v[52:55]
  s_waitcnt vmcnt(10)
  ds_read_b64_tr_b16 v[162:163], v120 offset:10240
  ds_read_b64_tr_b16 v[166:167], v120 offset:10248
  ds_read_b64_tr_b16 v[170:171], v121 offset:10240
  ds_read_b64_tr_b16 v[174:175], v121 offset:10248
  v_mfma_f32_16x16x32_bf16 v[56:59], a[216:219], v[92:95], v[56:59]
  v_mfma_f32_16x16x32_bf16 v[60:63], a[220:223], v[92:95], v[60:63]
  s_waitcnt lgkmcnt(6)
  v_mfma_f32_16x16x32_bf16 v[24:27], a[224:227], v[80:83], v[24:27]
  ds_read_b128 v[92:95], v109 offset:3072
  v_mfma_f32_16x16x32_bf16 v[28:31], a[228:231], v[80:83], v[28:31]
  v_mfma_f32_16x16x32_bf16 v[32:35], a[232:235], v[80:83], v[32:35]
  s_waitcnt lgkmcnt(1)
  s_add_u32 m0, s34, 8192
  s_mov_b32 s31, 155648
  buffer_load_dwordx4 v119, s[16:19], s31 offen offset:0 nt lds
  v_mfma_f32_16x16x32_bf16 v[36:39], a[236:239], v[80:83], v[36:39]
  v_mfma_f32_16x16x32_bf16 v[48:51], a[224:227], v[84:87], v[48:51]
  ds_read_b128 v[80:83], v109 offset:20992
  s_add_u32 m0, s34, 9216
  s_mov_b32 s31, 159744
  buffer_load_dwordx4 v119, s[16:19], s31 offen offset:0 nt lds
  v_mfma_f32_16x16x32_bf16 v[52:55], a[228:231], v[84:87], v[52:55]
  v_mfma_f32_16x16x32_bf16 v[56:59], a[232:235], v[84:87], v[56:59]
  v_mfma_f32_16x16x32_bf16 v[60:63], a[236:239], v[84:87], v[60:63]
  v_mfma_f32_16x16x32_bf16 v[24:27], a[240:243], v[88:91], v[24:27]
  ds_read_b128 v[84:87], v109 offset:33280
  v_mfma_f32_16x16x32_bf16 v[28:31], a[244:247], v[88:91], v[28:31]
  s_waitcnt vmcnt(10)
  ds_read_b64_tr_b16 v[176:177], v120 offset:12288
  ds_read_b64_tr_b16 v[180:181], v120 offset:12296
  ds_read_b64_tr_b16 v[184:185], v121 offset:12288
  ds_read_b64_tr_b16 v[188:189], v121 offset:12296
  v_mfma_f32_16x16x32_bf16 v[32:35], a[248:251], v[88:91], v[32:35]
  v_mfma_f32_16x16x32_bf16 v[36:39], a[252:255], v[88:91], v[36:39]
  s_waitcnt lgkmcnt(6)
  v_mfma_f32_16x16x32_bf16 v[48:51], a[240:243], v[92:95], v[48:51]
  ds_read_b128 v[88:91], v109 offset:45568
  v_mfma_f32_16x16x32_bf16 v[52:55], a[244:247], v[92:95], v[52:55]
  v_mfma_f32_16x16x32_bf16 v[56:59], a[248:251], v[92:95], v[56:59]
  s_waitcnt lgkmcnt(1)
  s_add_u32 m0, s34, 10240
  s_mov_b32 s31, 163840
  buffer_load_dwordx4 v119, s[16:19], s31 offen offset:0 nt lds
  v_mfma_f32_16x16x32_bf16 v[60:63], a[252:255], v[92:95], v[60:63]
  v_mfma_f32_16x16x32_bf16 v[0:3], v[128:131], v[80:83], v[0:3]
  ds_read_b128 v[92:95], v109 offset:4096
  s_add_u32 m0, s34, 11264
  s_mov_b32 s31, 167936
  buffer_load_dwordx4 v119, s[16:19], s31 offen offset:0 nt lds
  v_mfma_f32_16x16x32_bf16 v[4:7], v[132:135], v[80:83], v[4:7]
  v_mfma_f32_16x16x32_bf16 v[8:11], v[136:139], v[80:83], v[8:11]
  v_mfma_f32_16x16x32_bf16 v[12:15], v[140:143], v[80:83], v[12:15]
  v_mfma_f32_16x16x32_bf16 v[64:67], v[128:131], v[84:87], v[64:67]
  ds_read_b128 v[80:83], v109 offset:22016
  v_mfma_f32_16x16x32_bf16 v[68:71], v[132:135], v[84:87], v[68:71]
  s_waitcnt vmcnt(10)
  ds_read_b64_tr_b16 v[178:179], v120 offset:0
  ds_read_b64_tr_b16 v[182:183], v120 offset:8
  ds_read_b64_tr_b16 v[186:187], v121 offset:0
  ds_read_b64_tr_b16 v[190:191], v121 offset:8
  v_mfma_f32_16x16x32_bf16 v[72:75], v[136:139], v[84:87], v[72:75]
  v_mfma_f32_16x16x32_bf16 v[76:79], v[140:143], v[84:87], v[76:79]
  s_waitcnt lgkmcnt(6)
  v_mfma_f32_16x16x32_bf16 v[24:27], v[128:131], v[88:91], v[24:27]
  ds_read_b128 v[84:87], v109 offset:34304
  v_mfma_f32_16x16x32_bf16 v[28:31], v[132:135], v[88:91], v[28:31]
  v_mfma_f32_16x16x32_bf16 v[32:35], v[136:139], v[88:91], v[32:35]
  s_waitcnt lgkmcnt(1)
  s_add_u32 m0, s34, 12288
  s_mov_b32 s31, 172032
  buffer_load_dwordx4 v119, s[16:19], s31 offen offset:0 nt lds
  v_mfma_f32_16x16x32_bf16 v[36:39], v[140:143], v[88:91], v[36:39]
  v_mfma_f32_16x16x32_bf16 v[48:51], v[128:131], v[92:95], v[48:51]
  ds_read_b128 v[88:91], v109 offset:46592
  s_add_u32 m0, s34, 13312
  s_mov_b32 s31, 176128
  buffer_load_dwordx4 v119, s[16:19], s31 offen offset:0 nt lds
  v_mfma_f32_16x16x32_bf16 v[52:55], v[132:135], v[92:95], v[52:55]
  v_mfma_f32_16x16x32_bf16 v[56:59], v[136:139], v[92:95], v[56:59]
  v_mfma_f32_16x16x32_bf16 v[60:63], v[140:143], v[92:95], v[60:63]
  v_mfma_f32_16x16x32_bf16 v[0:3], v[144:147], v[80:83], v[0:3]
  ds_read_b128 v[92:95], v109 offset:5120
  v_mfma_f32_16x16x32_bf16 v[4:7], v[148:151], v[80:83], v[4:7]
  s_waitcnt vmcnt(10)
  ds_read_b64_tr_b16 v[192:193], v120 offset:2048
  ds_read_b64_tr_b16 v[196:197], v120 offset:2056
  ds_read_b64_tr_b16 v[200:201], v121 offset:2048
  ds_read_b64_tr_b16 v[204:205], v121 offset:2056
  v_mfma_f32_16x16x32_bf16 v[8:11], v[152:155], v[80:83], v[8:11]
  v_mfma_f32_16x16x32_bf16 v[12:15], v[156:159], v[80:83], v[12:15]
  s_waitcnt lgkmcnt(6)
  v_mfma_f32_16x16x32_bf16 v[64:67], v[144:147], v[84:87], v[64:67]
  ds_read_b128 v[80:83], v109 offset:23040
  v_mfma_f32_16x16x32_bf16 v[68:71], v[148:151], v[84:87], v[68:71]
  v_mfma_f32_16x16x32_bf16 v[72:75], v[152:155], v[84:87], v[72:75]
  s_waitcnt lgkmcnt(1)
  s_add_u32 m0, s34, 0
  s_mov_b32 s31, 180224
  buffer_load_dwordx4 v119, s[16:19], s31 offen offset:0 nt lds
  v_mfma_f32_16x16x32_bf16 v[76:79], v[156:159], v[84:87], v[76:79]
  v_mfma_f32_16x16x32_bf16 v[24:27], v[144:147], v[88:91], v[24:27]
  ds_read_b128 v[84:87], v109 offset:35328
  s_add_u32 m0, s34, 1024
  s_mov_b32 s31, 184320
  buffer_load_dwordx4 v119, s[16:19], s31 offen offset:0 nt lds
  v_mfma_f32_16x16x32_bf16 v[28:31], v[148:151], v[88:91], v[28:31]
  v_mfma_f32_16x16x32_bf16 v[32:35], v[152:155], v[88:91], v[32:35]
  v_mfma_f32_16x16x32_bf16 v[36:39], v[156:159], v[88:91], v[36:39]
  v_mfma_f32_16x16x32_bf16 v[48:51], v[144:147], v[92:95], v[48:51]
  ds_read_b128 v[88:91], v109 offset:47616
  v_mfma_f32_16x16x32_bf16 v[52:55], v[148:151], v[92:95], v[52:55]
  s_waitcnt vmcnt(10)
  ds_read_b64_tr_b16 v[194:195], v120 offset:4096
  ds_read_b64_tr_b16 v[198:199], v120 offset:4104
  ds_read_b64_tr_b16 v[202:203], v121 offset:4096
  ds_read_b64_tr_b16 v[206:207], v121 offset:4104
  v_mfma_f32_16x16x32_bf16 v[56:59], v[152:155], v[92:95], v[56:59]
  v_mfma_f32_16x16x32_bf16 v[60:63], v[156:159], v[92:95], v[60:63]
  s_waitcnt lgkmcnt(6)
  v_mfma_f32_16x16x32_bf16 v[0:3], v[160:163], v[80:83], v[0:3]
  ds_read_b128 v[92:95], v109 offset:6144
  v_mfma_f32_16x16x32_bf16 v[4:7], v[164:167], v[80:83], v[4:7]
  v_mfma_f32_16x16x32_bf16 v[8:11], v[168:171], v[80:83], v[8:11]
  s_waitcnt lgkmcnt(1)
  s_add_u32 m0, s34, 2048
  s_mov_b32 s31, 188416
  buffer_load_dwordx4 v119, s[16:19], s31 offen offset:0 nt lds
  v_mfma_f32_16x16x32_bf16 v[12:15], v[172:175], v[80:83], v[12:15]
  v_mfma_f32_16x16x32_bf16 v[64:67], v[160:163], v[84:87], v[64:67]
  ds_read_b128 v[80:83], v109 offset:24064
  s_add_u32 m0, s34, 3072
  s_mov_b32 s31, 192512
  buffer_load_dwordx4 v119, s[16:19], s31 offen offset:0 nt lds
  v_mfma_f32_16x16x32_bf16 v[68:71], v[164:167], v[84:87], v[68:71]
  v_mfma_f32_16x16x32_bf16 v[72:75], v[168:171], v[84:87], v[72:75]
  v_mfma_f32_16x16x32_bf16 v[76:79], v[172:175], v[84:87], v[76:79]
  v_mfma_f32_16x16x32_bf16 v[24:27], v[160:163], v[88:91], v[24:27]
  ds_read_b128 v[84:87], v109 offset:36352
  v_mfma_f32_16x16x32_bf16 v[28:31], v[164:167], v[88:91], v[28:31]
  s_waitcnt vmcnt(10)
  ds_read_b64_tr_b16 v[208:209], v120 offset:6144
  ds_read_b64_tr_b16 v[212:213], v120 offset:6152
  ds_read_b64_tr_b16 v[216:217], v121 offset:6144
  ds_read_b64_tr_b16 v[220:221], v121 offset:6152
  v_mfma_f32_16x16x32_bf16 v[32:35], v[168:171], v[88:91], v[32:35]
  v_mfma_f32_16x16x32_bf16 v[36:39], v[172:175], v[88:91], v[36:39]
  s_waitcnt lgkmcnt(6)
  v_mfma_f32_16x16x32_bf16 v[48:51], v[160:163], v[92:95], v[48:51]
  ds_read_b128 v[88:91], v109 offset:48640
  v_mfma_f32_16x16x32_bf16 v[52:55], v[164:167], v[92:95], v[52:55]
  v_mfma_f32_16x16x32_bf16 v[56:59], v[168:171], v[92:95], v[56:59]
  s_waitcnt lgkmcnt(1)
  s_add_u32 m0, s29, 0
  s_mov_b32 s31, 32768
  buffer_load_dwordx4 v113, s[8:11], s31 offen offset:0 nt lds
  v_mfma_f32_16x16x32_bf16 v[60:63], v[172:175], v[92:95], v[60:63]
  v_mfma_f32_16x16x32_bf16 v[0:3], v[176:179], v[80:83], v[0:3]
  ds_read_b128 v[92:95], v109 offset:7168
  s_add_u32 m0, s29, 32
  s_mov_b32 s31, 32768
  buffer_load_dwordx4 v113, s[8:11], s31 offen offset:1024 nt lds
  v_mfma_f32_16x16x32_bf16 v[4:7], v[180:183], v[80:83], v[4:7]
  v_mfma_f32_16x16x32_bf16 v[8:11], v[184:187], v[80:83], v[8:11]
  v_mfma_f32_16x16x32_bf16 v[12:15], v[188:191], v[80:83], v[12:15]
  v_mfma_f32_16x16x32_bf16 v[64:67], v[176:179], v[84:87], v[64:67]
  ds_read_b128 v[80:83], v109 offset:25088
  v_mfma_f32_16x16x32_bf16 v[68:71], v[180:183], v[84:87], v[68:71]
  s_waitcnt vmcnt(10)
  ds_read_b64_tr_b16 v[210:211], v120 offset:8192
  ds_read_b64_tr_b16 v[214:215], v120 offset:8200
  ds_read_b64_tr_b16 v[218:219], v121 offset:8192
  ds_read_b64_tr_b16 v[222:223], v121 offset:8200
  v_mfma_f32_16x16x32_bf16 v[72:75], v[184:187], v[84:87], v[72:75]
  v_mfma_f32_16x16x32_bf16 v[76:79], v[188:191], v[84:87], v[76:79]
  s_waitcnt lgkmcnt(6)
  v_mfma_f32_16x16x32_bf16 v[24:27], v[176:179], v[88:91], v[24:27]
  ds_read_b128 v[84:87], v109 offset:37376
  v_mfma_f32_16x16x32_bf16 v[28:31], v[180:183], v[88:91], v[28:31]
  v_mfma_f32_16x16x32_bf16 v[32:35], v[184:187], v[88:91], v[32:35]
  s_waitcnt lgkmcnt(1)
  s_add_u32 m0, s29, 8448
  s_mov_b32 s31, 40960
  buffer_load_dwordx4 v113, s[8:11], s31 offen offset:0 nt lds
  v_mfma_f32_16x16x32_bf16 v[36:39], v[188:191], v[88:91], v[36:39]
  v_mfma_f32_16x16x32_bf16 v[48:51], v[176:179], v[92:95], v[48:51]
  ds_read_b128 v[88:91], v109 offset:49664
  s_add_u32 m0, s29, 8480
  s_mov_b32 s31, 40960
  buffer_load_dwordx4 v113, s[8:11], s31 offen offset:1024 nt lds
  v_mfma_f32_16x16x32_bf16 v[52:55], v[180:183], v[92:95], v[52:55]
  v_mfma_f32_16x16x32_bf16 v[56:59], v[184:187], v[92:95], v[56:59]
  v_mfma_f32_16x16x32_bf16 v[60:63], v[188:191], v[92:95], v[60:63]
  v_mfma_f32_16x16x32_bf16 v[0:3], v[192:195], v[80:83], v[0:3]
  ds_read_b128 v[92:95], v109 offset:8192
  v_mfma_f32_16x16x32_bf16 v[4:7], v[196:199], v[80:83], v[4:7]
  s_waitcnt vmcnt(10)
  ds_read_b64_tr_b16 v[224:225], v120 offset:10240
  ds_read_b64_tr_b16 v[228:229], v120 offset:10248
  ds_read_b64_tr_b16 v[232:233], v121 offset:10240
  ds_read_b64_tr_b16 v[236:237], v121 offset:10248
  v_mfma_f32_16x16x32_bf16 v[8:11], v[200:203], v[80:83], v[8:11]
  v_mfma_f32_16x16x32_bf16 v[12:15], v[204:207], v[80:83], v[12:15]
  s_waitcnt lgkmcnt(6)
  v_mfma_f32_16x16x32_bf16 v[64:67], v[192:195], v[84:87], v[64:67]
  ds_read_b128 v[80:83], v109 offset:26112
  v_mfma_f32_16x16x32_bf16 v[68:71], v[196:199], v[84:87], v[68:71]
  v_mfma_f32_16x16x32_bf16 v[72:75], v[200:203], v[84:87], v[72:75]
  s_waitcnt lgkmcnt(1)
  s_add_u32 m0, s29, 16896
  s_mov_b32 s31, 49152
  buffer_load_dwordx4 v113, s[8:11], s31 offen offset:0 nt lds
  v_mfma_f32_16x16x32_bf16 v[76:79], v[204:207], v[84:87], v[76:79]
  v_mfma_f32_16x16x32_bf16 v[24:27], v[192:195], v[88:91], v[24:27]
  ds_read_b128 v[84:87], v109 offset:38400
  s_add_u32 m0, s29, 16928
  s_mov_b32 s31, 49152
  buffer_load_dwordx4 v113, s[8:11], s31 offen offset:1024 nt lds
  v_mfma_f32_16x16x32_bf16 v[28:31], v[196:199], v[88:91], v[28:31]
  v_mfma_f32_16x16x32_bf16 v[32:35], v[200:203], v[88:91], v[32:35]
  v_mfma_f32_16x16x32_bf16 v[36:39], v[204:207], v[88:91], v[36:39]
  v_mfma_f32_16x16x32_bf16 v[48:51], v[192:195], v[92:95], v[48:51]
  ds_read_b128 v[88:91], v109 offset:50688
  v_mfma_f32_16x16x32_bf16 v[52:55], v[196:199], v[92:95], v[52:55]
  s_waitcnt vmcnt(10)
  ds_read_b64_tr_b16 v[226:227], v120 offset:12288
  ds_read_b64_tr_b16 v[230:231], v120 offset:12296
  ds_read_b64_tr_b16 v[234:235], v121 offset:12288
  ds_read_b64_tr_b16 v[238:239], v121 offset:12296
  v_mfma_f32_16x16x32_bf16 v[56:59], v[200:203], v[92:95], v[56:59]
  v_mfma_f32_16x16x32_bf16 v[60:63], v[204:207], v[92:95], v[60:63]
  s_waitcnt lgkmcnt(6)
  v_mfma_f32_16x16x32_bf16 v[0:3], v[208:211], v[80:83], v[0:3]
  ds_read_b128 v[92:95], v109 offset:9216
  v_mfma_f32_16x16x32_bf16 v[4:7], v[212:215], v[80:83], v[4:7]
  v_mfma_f32_16x16x32_bf16 v[8:11], v[216:219], v[80:83], v[8:11]
  s_waitcnt lgkmcnt(1)
  s_add_u32 m0, s29, 25344
  s_mov_b32 s31, 57344
  buffer_load_dwordx4 v113, s[8:11], s31 offen offset:0 nt lds
  v_mfma_f32_16x16x32_bf16 v[12:15], v[220:223], v[80:83], v[12:15]
  v_mfma_f32_16x16x32_bf16 v[64:67], v[208:211], v[84:87], v[64:67]
  ds_read_b128 v[80:83], v109 offset:27136
  s_add_u32 m0, s29, 25376
  s_mov_b32 s31, 57344
  buffer_load_dwordx4 v113, s[8:11], s31 offen offset:1024 nt lds
  v_mfma_f32_16x16x32_bf16 v[68:71], v[212:215], v[84:87], v[68:71]
  v_mfma_f32_16x16x32_bf16 v[72:75], v[216:219], v[84:87], v[72:75]
  v_mfma_f32_16x16x32_bf16 v[76:79], v[220:223], v[84:87], v[76:79]
  v_mfma_f32_16x16x32_bf16 v[24:27], v[208:211], v[88:91], v[24:27]
  ds_read_b128 v[84:87], v109 offset:39424
  v_mfma_f32_16x16x32_bf16 v[28:31], v[212:215], v[88:91], v[28:31]
  s_waitcnt vmcnt(10)
  ds_read_b64_tr_b16 v[240:241], v120 offset:0
  ds_read_b64_tr_b16 v[244:245], v120 offset:8
  ds_read_b64_tr_b16 v[248:249], v121 offset:0
  ds_read_b64_tr_b16 v[252:253], v121 offset:8
  v_mfma_f32_16x16x32_bf16 v[32:35], v[216:219], v[88:91], v[32:35]
  v_mfma_f32_16x16x32_bf16 v[36:39], v[220:223], v[88:91], v[36:39]
  s_waitcnt lgkmcnt(6)
  v_mfma_f32_16x16x32_bf16 v[48:51], v[208:211], v[92:95], v[48:51]
  ds_read_b128 v[88:91], v109 offset:51712
  v_mfma_f32_16x16x32_bf16 v[52:55], v[212:215], v[92:95], v[52:55]
  v_mfma_f32_16x16x32_bf16 v[56:59], v[216:219], v[92:95], v[56:59]
  v_mfma_f32_16x16x32_bf16 v[60:63], v[220:223], v[92:95], v[60:63]
  s_waitcnt lgkmcnt(6)
  v_mfma_f32_16x16x32_bf16 v[0:3], v[224:227], v[80:83], v[0:3]
  ds_read_b128 v[92:95], v109 offset:10240
  v_mfma_f32_16x16x32_bf16 v[4:7], v[228:231], v[80:83], v[4:7]
  v_mfma_f32_16x16x32_bf16 v[8:11], v[232:235], v[80:83], v[8:11]
  v_mfma_f32_16x16x32_bf16 v[12:15], v[236:239], v[80:83], v[12:15]
  s_waitcnt lgkmcnt(6)
  v_mfma_f32_16x16x32_bf16 v[64:67], v[224:227], v[84:87], v[64:67]
  ds_read_b128 v[80:83], v109 offset:28160
  v_mfma_f32_16x16x32_bf16 v[68:71], v[228:231], v[84:87], v[68:71]
  s_waitcnt vmcnt(8)
  ds_read_b64_tr_b16 v[242:243], v120 offset:2048
  ds_read_b64_tr_b16 v[246:247], v120 offset:2056
  ds_read_b64_tr_b16 v[250:251], v121 offset:2048
  ds_read_b64_tr_b16 v[254:255], v121 offset:2056
  v_mfma_f32_16x16x32_bf16 v[72:75], v[232:235], v[84:87], v[72:75]
  v_mfma_f32_16x16x32_bf16 v[76:79], v[236:239], v[84:87], v[76:79]
  s_waitcnt lgkmcnt(6)
  v_mfma_f32_16x16x32_bf16 v[24:27], v[224:227], v[88:91], v[24:27]
  ds_read_b128 v[84:87], v109 offset:40448
  v_mfma_f32_16x16x32_bf16 v[28:31], v[228:231], v[88:91], v[28:31]
  v_mfma_f32_16x16x32_bf16 v[32:35], v[232:235], v[88:91], v[32:35]
  v_mfma_f32_16x16x32_bf16 v[36:39], v[236:239], v[88:91], v[36:39]
  s_waitcnt lgkmcnt(6)
  v_mfma_f32_16x16x32_bf16 v[48:51], v[224:227], v[92:95], v[48:51]
  ds_read_b128 v[88:91], v109 offset:52736
  v_mfma_f32_16x16x32_bf16 v[52:55], v[228:231], v[92:95], v[52:55]
  v_mfma_f32_16x16x32_bf16 v[56:59], v[232:235], v[92:95], v[56:59]
  v_mfma_f32_16x16x32_bf16 v[60:63], v[236:239], v[92:95], v[60:63]
  s_waitcnt lgkmcnt(5)
  v_mfma_f32_16x16x32_bf16 v[0:3], v[240:243], v[80:83], v[0:3]
  ds_read_b128 v[92:95], v109 offset:11264
  s_waitcnt lgkmcnt(5)
  v_mfma_f32_16x16x32_bf16 v[4:7], v[244:247], v[80:83], v[4:7]
  s_waitcnt lgkmcnt(4)
  v_mfma_f32_16x16x32_bf16 v[8:11], v[248:251], v[80:83], v[8:11]
  s_waitcnt lgkmcnt(3)
  v_mfma_f32_16x16x32_bf16 v[12:15], v[252:255], v[80:83], v[12:15]
  s_waitcnt lgkmcnt(2)
  v_mfma_f32_16x16x32_bf16 v[64:67], v[240:243], v[84:87], v[64:67]
  v_mfma_f32_16x16x32_bf16 v[68:71], v[244:247], v[84:87], v[68:71]
  v_mfma_f32_16x16x32_bf16 v[72:75], v[248:251], v[84:87], v[72:75]
  v_mfma_f32_16x16x32_bf16 v[76:79], v[252:255], v[84:87], v[76:79]
  v_mov_b32_dpp v125, v122 row_ror:8 row_mask:0xf bank_mask:0xf
  v_mul_f32 v0, v122, v0
  v_mul_f32 v1, v122, v1
  v_mul_f32 v2, v122, v2
  s_waitcnt lgkmcnt(1)
  v_mfma_f32_16x16x32_bf16 v[24:27], v[240:243], v[88:91], v[24:27]
  v_mul_f32 v3, v122, v3
  v_cvt_pk_bf16_f32 v0, v0, v1
  v_mul_f32 v4, v122, v4
  v_mul_f32 v5, v122, v5
  v_mfma_f32_16x16x32_bf16 v[28:31], v[244:247], v[88:91], v[28:31]
  v_cvt_pk_bf16_f32 v1, v2, v3
  v_mul_f32 v6, v122, v6
  v_mul_f32 v7, v122, v7
  v_cvt_pk_bf16_f32 v2, v4, v5
  v_mfma_f32_16x16x32_bf16 v[32:35], v[248:251], v[88:91], v[32:35]
  v_cvt_pk_bf16_f32 v3, v6, v7
  v_mul_f32_dpp v8, v8, v125 row_ror:8 row_mask:0xf bank_mask:0xf
  v_mul_f32_dpp v9, v9, v125 row_ror:8 row_mask:0xf bank_mask:0xf
  v_mul_f32_dpp v10, v10, v125 row_ror:8 row_mask:0xf bank_mask:0xf
  v_mfma_f32_16x16x32_bf16 v[36:39], v[252:255], v[88:91], v[36:39]
  v_mul_f32_dpp v11, v11, v125 row_ror:8 row_mask:0xf bank_mask:0xf
  v_cvt_pk_bf16_f32 v8, v8, v9
  v_mul_f32_dpp v12, v12, v125 row_ror:8 row_mask:0xf bank_mask:0xf
  v_mul_f32_dpp v13, v13, v125 row_ror:8 row_mask:0xf bank_mask:0xf
  s_waitcnt lgkmcnt(0)
  v_mfma_f32_16x16x32_bf16 v[48:51], v[240:243], v[92:95], v[48:51]
  v_cvt_pk_bf16_f32 v9, v10, v11
  v_mfma_f32_16x16x32_bf16 v[52:55], v[244:247], v[92:95], v[52:55]
  v_mfma_f32_16x16x32_bf16 v[56:59], v[248:251], v[92:95], v[56:59]
  v_mfma_f32_16x16x32_bf16 v[60:63], v[252:255], v[92:95], v[60:63]
  v_mul_f32_dpp v14, v14, v125 row_ror:8 row_mask:0xf bank_mask:0xf
  v_mul_f32_dpp v15, v15, v125 row_ror:8 row_mask:0xf bank_mask:0xf
  v_cvt_pk_bf16_f32 v10, v12, v13
  v_cvt_pk_bf16_f32 v11, v14, v15
  s_waitcnt vmcnt(6)
  s_barrier
  ds_read_b128 v[80:83], v108 offset:0
  ds_read_b128 v[84:87], v108 offset:64
  ds_read_b128 v[88:91], v108 offset:128
  ds_read_b128 v[92:95], v108 offset:192
  v_cndmask_b32_e64 v4, v0, v8, s[88:89]
  v_cndmask_b32_e64 v5, v1, v9, s[88:89]
  v_cndmask_b32_e64 v6, v2, v10, s[88:89]
  v_cndmask_b32_e64 v7, v3, v11, s[88:89]
  buffer_store_dwordx4 v[4:7], v114, s[20:23], s84 offen offset:0 sc1
  v_cndmask_b32_e64 v12, v8, v0, s[88:89]
  v_cndmask_b32_e64 v13, v9, v1, s[88:89]
  v_cndmask_b32_e64 v14, v10, v2, s[88:89]
  v_cndmask_b32_e64 v15, v11, v3, s[88:89]
  buffer_store_dwordx4 v[12:15], v127, s[20:23], s84 offen offset:0 sc1
  v_mov_b32_dpp v125, v123 row_ror:8 row_mask:0xf bank_mask:0xf
  v_mul_f32 v64, v123, v64
  v_mul_f32 v65, v123, v65
  v_mul_f32 v66, v123, v66
  v_mul_f32 v67, v123, v67
  v_cvt_pk_bf16_f32 v64, v64, v65
  v_mul_f32 v68, v123, v68
  v_mul_f32 v69, v123, v69
  v_cvt_pk_bf16_f32 v65, v66, v67
  v_mul_f32 v70, v123, v70
  v_mul_f32 v71, v123, v71
  v_cvt_pk_bf16_f32 v66, v68, v69
  v_cvt_pk_bf16_f32 v67, v70, v71
  s_waitcnt lgkmcnt(0)
  v_mfma_f32_16x16x32_bf16 v[0:3], a[0:3], v[80:83], 0
  v_mul_f32_dpp v72, v72, v125 row_ror:8 row_mask:0xf bank_mask:0xf
  v_mul_f32_dpp v73, v73, v125 row_ror:8 row_mask:0xf bank_mask:0xf
  v_mul_f32_dpp v74, v74, v125 row_ror:8 row_mask:0xf bank_mask:0xf
  v_mul_f32_dpp v75, v75, v125 row_ror:8 row_mask:0xf bank_mask:0xf
  v_mfma_f32_16x16x32_bf16 v[0:3], a[4:7], v[84:87], v[0:3]
  v_cvt_pk_bf16_f32 v72, v72, v73
  v_mul_f32_dpp v76, v76, v125 row_ror:8 row_mask:0xf bank_mask:0xf
  v_mfma_f32_16x16x32_bf16 v[0:3], a[8:11], v[88:91], v[0:3]
  v_mul_f32_dpp v77, v77, v125 row_ror:8 row_mask:0xf bank_mask:0xf
  v_cvt_pk_bf16_f32 v73, v74, v75
  v_mfma_f32_16x16x32_bf16 v[0:3], a[12:15], v[92:95], v[0:3]
  v_mul_f32_dpp v78, v78, v125 row_ror:8 row_mask:0xf bank_mask:0xf
  v_mul_f32_dpp v79, v79, v125 row_ror:8 row_mask:0xf bank_mask:0xf
  v_mfma_f32_16x16x32_bf16 v[4:7], a[32:35], v[80:83], 0
  v_cvt_pk_bf16_f32 v74, v76, v77
  v_cvt_pk_bf16_f32 v75, v78, v79
  v_mfma_f32_16x16x32_bf16 v[4:7], a[36:39], v[84:87], v[4:7]
  v_cndmask_b32_e64 v104, v64, v72, s[88:89]
  v_cndmask_b32_e64 v105, v65, v73, s[88:89]
  v_mfma_f32_16x16x32_bf16 v[4:7], a[40:43], v[88:91], v[4:7]
  v_cndmask_b32_e64 v106, v66, v74, s[88:89]
  v_cndmask_b32_e64 v107, v67, v75, s[88:89]
  v_mfma_f32_16x16x32_bf16 v[4:7], a[44:47], v[92:95], v[4:7]
  v_cndmask_b32_e64 v100, v72, v64, s[88:89]
  v_cndmask_b32_e64 v101, v73, v65, s[88:89]
  v_mfma_f32_16x16x32_bf16 v[8:11], a[64:67], v[80:83], 0
  v_cndmask_b32_e64 v102, v74, v66, s[88:89]
  v_cndmask_b32_e64 v103, v75, v67, s[88:89]
  v_mfma_f32_16x16x32_bf16 v[8:11], a[68:71], v[84:87], v[8:11]
  v_mov_b32_dpp v125, v124 row_ror:8 row_mask:0xf bank_mask:0xf
  v_mul_f32 v24, v124, v24
  v_mfma_f32_16x16x32_bf16 v[8:11], a[72:75], v[88:91], v[8:11]
  ds_read_b128 v[64:67], v108 offset:256
  ds_read_b128 v[68:71], v108 offset:320
  v_mfma_f32_16x16x32_bf16 v[8:11], a[76:79], v[92:95], v[8:11]
  ds_read_b128 v[72:75], v108 offset:384
  ds_read_b128 v[76:79], v108 offset:448
  v_mfma_f32_16x16x32_bf16 v[12:15], a[96:99], v[80:83], 0
  v_mul_f32 v25, v124, v25
  v_mul_f32 v26, v124, v26
  v_mfma_f32_16x16x32_bf16 v[12:15], a[100:103], v[84:87], v[12:15]
  v_mul_f32 v27, v124, v27
  v_cvt_pk_bf16_f32 v24, v24, v25
  v_mfma_f32_16x16x32_bf16 v[12:15], a[104:107], v[88:91], v[12:15]
  buffer_store_dwordx4 v[104:107], v114, s[20:23], s85 offen offset:0 sc1
  v_mfma_f32_16x16x32_bf16 v[12:15], a[108:111], v[92:95], v[12:15]
  v_mul_f32 v28, v124, v28
  v_mul_f32 v29, v124, v29
  v_mfma_f32_16x16x32_bf16 v[16:19], a[128:131], v[80:83], 0
  v_cvt_pk_bf16_f32 v25, v26, v27
  v_mul_f32 v30, v124, v30
  v_mfma_f32_16x16x32_bf16 v[16:19], a[132:135], v[84:87], v[16:19]
  v_mul_f32 v31, v124, v31
  v_cvt_pk_bf16_f32 v26, v28, v29
  v_mfma_f32_16x16x32_bf16 v[16:19], a[136:139], v[88:91], v[16:19]
  buffer_store_dwordx4 v[100:103], v127, s[20:23], s85 offen offset:0 sc1
  v_mfma_f32_16x16x32_bf16 v[16:19], a[140:143], v[92:95], v[16:19]
  v_cvt_pk_bf16_f32 v27, v30, v31
  v_mul_f32_dpp v32, v32, v125 row_ror:8 row_mask:0xf bank_mask:0xf
  v_mfma_f32_16x16x32_bf16 v[20:23], a[160:163], v[80:83], 0
  v_mul_f32_dpp v33, v33, v125 row_ror:8 row_mask:0xf bank_mask:0xf
  v_mul_f32_dpp v34, v34, v125 row_ror:8 row_mask:0xf bank_mask:0xf
  v_mfma_f32_16x16x32_bf16 v[20:23], a[164:167], v[84:87], v[20:23]
  v_mul_f32_dpp v35, v35, v125 row_ror:8 row_mask:0xf bank_mask:0xf
  v_cvt_pk_bf16_f32 v32, v32, v33
  v_mfma_f32_16x16x32_bf16 v[20:23], a[168:171], v[88:91], v[20:23]
  v_mul_f32_dpp v36, v36, v125 row_ror:8 row_mask:0xf bank_mask:0xf
  v_mul_f32_dpp v37, v37, v125 row_ror:8 row_mask:0xf bank_mask:0xf
  v_mfma_f32_16x16x32_bf16 v[20:23], a[172:175], v[92:95], v[20:23]
  v_cvt_pk_bf16_f32 v33, v34, v35
  v_mul_f32_dpp v38, v38, v125 row_ror:8 row_mask:0xf bank_mask:0xf
  s_waitcnt lgkmcnt(0)
  v_mfma_f32_16x16x32_bf16 v[0:3], a[16:19], v[64:67], v[0:3]
  v_mul_f32_dpp v39, v39, v125 row_ror:8 row_mask:0xf bank_mask:0xf
  v_cvt_pk_bf16_f32 v34, v36, v37
  v_mfma_f32_16x16x32_bf16 v[0:3], a[20:23], v[68:71], v[0:3]
  v_cvt_pk_bf16_f32 v35, v38, v39
  v_mfma_f32_16x16x32_bf16 v[0:3], a[24:27], v[72:75], v[0:3]
  v_mfma_f32_16x16x32_bf16 v[0:3], a[28:31], v[76:79], v[0:3]
  v_mfma_f32_16x16x32_bf16 v[4:7], a[48:51], v[64:67], v[4:7]
  v_mfma_f32_16x16x32_bf16 v[4:7], a[52:55], v[68:71], v[4:7]
  v_mfma_f32_16x16x32_bf16 v[4:7], a[56:59], v[72:75], v[4:7]
  s_waitcnt vmcnt(8)
  s_barrier
  v_mfma_f32_16x16x32_bf16 v[4:7], a[60:63], v[76:79], v[4:7]
  ds_read_b128 v[80:83], v108 offset:8448
  ds_read_b128 v[84:87], v108 offset:8512
  v_mfma_f32_16x16x32_bf16 v[8:11], a[80:83], v[64:67], v[8:11]
  ds_read_b128 v[88:91], v108 offset:8576
  ds_read_b128 v[92:95], v108 offset:8640
  v_mfma_f32_16x16x32_bf16 v[8:11], a[84:87], v[68:71], v[8:11]
  v_max3_f32 v115, v0, v1, v2
  v_mfma_f32_16x16x32_bf16 v[8:11], a[88:91], v[72:75], v[8:11]
  s_add_u32 m0, s29, 33792
  s_mov_b32 s31, 65536
  buffer_load_dwordx4 v113, s[8:11], s31 offen offset:0 nt lds
  v_mfma_f32_16x16x32_bf16 v[8:11], a[92:95], v[76:79], v[8:11]
  v_max3_f32 v115, v115, v3, v4
  v_max3_f32 v115, v115, v5, v6
  v_mfma_f32_16x16x32_bf16 v[12:15], a[112:115], v[64:67], v[12:15]
  v_mfma_f32_16x16x32_bf16 v[12:15], a[116:119], v[68:71], v[12:15]
  v_mfma_f32_16x16x32_bf16 v[12:15], a[120:123], v[72:75], v[12:15]
  v_mfma_f32_16x16x32_bf16 v[12:15], a[124:127], v[76:79], v[12:15]
  s_nop 1
  v_max3_f32 v115, v115, v7, v8
  v_max3_f32 v115, v115, v9, v10
  v_mfma_f32_16x16x32_bf16 v[16:19], a[144:147], v[64:67], v[16:19]
  s_add_u32 m0, s29, 33824
  s_mov_b32 s31, 65536
  buffer_load_dwordx4 v113, s[8:11], s31 offen offset:1024 nt lds
  v_mfma_f32_16x16x32_bf16 v[16:19], a[148:151], v[68:71], v[16:19]
  v_mfma_f32_16x16x32_bf16 v[16:19], a[152:155], v[72:75], v[16:19]
  v_mfma_f32_16x16x32_bf16 v[16:19], a[156:159], v[76:79], v[16:19]
  v_max3_f32 v115, v115, v11, v12
  v_max3_f32 v115, v115, v13, v14
  v_mfma_f32_16x16x32_bf16 v[20:23], a[176:179], v[64:67], v[20:23]
  v_mfma_f32_16x16x32_bf16 v[20:23], a[180:183], v[68:71], v[20:23]
  v_mfma_f32_16x16x32_bf16 v[20:23], a[184:187], v[72:75], v[20:23]
  v_mfma_f32_16x16x32_bf16 v[20:23], a[188:191], v[76:79], v[20:23]
  s_nop 1
  v_max3_f32 v115, v115, v15, v16
  v_max3_f32 v115, v115, v17, v18
  s_nop 3
  v_max3_f32 v115, v115, v19, v20
  v_max3_f32 v115, v115, v21, v22
  v_max_f32 v115, v115, v23
  ds_write_b32 v112, v115 offset:0
  ds_max_f32 v112, v115 offset:0
  v_cndmask_b32_e64 v28, v24, v32, s[88:89]
  v_cndmask_b32_e64 v29, v25, v33, s[88:89]
  v_cndmask_b32_e64 v30, v26, v34, s[88:89]
  v_cndmask_b32_e64 v31, v27, v35, s[88:89]
  v_cndmask_b32_e64 v36, v32, v24, s[88:89]
  v_cndmask_b32_e64 v37, v33, v25, s[88:89]
  v_cndmask_b32_e64 v38, v34, v26, s[88:89]
  v_cndmask_b32_e64 v39, v35, v27, s[88:89]
  s_waitcnt vmcnt(8) lgkmcnt(0)
  s_barrier
  v_mfma_f32_16x16x32_bf16 v[24:27], a[0:3], v[80:83], 0
  ds_read_b128 v[104:107], v111 offset:0
  ds_read_b128 v[100:103], v111 offset:768
  buffer_store_dwordx4 v[28:31], v114, s[20:23], s86 offen offset:0 sc1
  v_mfma_f32_16x16x32_bf16 v[24:27], a[4:7], v[84:87], v[24:27]
  ds_read_b128 v[64:67], v108 offset:8704
  ds_read_b128 v[68:71], v108 offset:8768
  ds_read_b128 v[72:75], v108 offset:8832
  v_mfma_f32_16x16x32_bf16 v[24:27], a[8:11], v[88:91], v[24:27]
  ds_read_b128 v[76:79], v108 offset:8896
  v_mfma_f32_16x16x32_bf16 v[24:27], a[12:15], v[92:95], v[24:27]
  v_mfma_f32_16x16x32_bf16 v[28:31], a[32:35], v[80:83], 0
  buffer_store_dwordx4 v[36:39], v127, s[20:23], s86 offen offset:0 sc1
  v_mfma_f32_16x16x32_bf16 v[28:31], a[36:39], v[84:87], v[28:31]
  s_waitcnt lgkmcnt(5)
  v_max3_f32 v116, v104, v105, v106
  v_max_f32 v116, v116, v107
  v_mul_f32 v116, s24, v116
  v_mfma_f32_16x16x32_bf16 v[28:31], a[40:43], v[88:91], v[28:31]
  s_waitcnt lgkmcnt(4)
  v_add_f32 v100, v100, v101
  v_add_f32 v102, v102, v103
  v_add_f32 v117, v100, v102
  v_mfma_f32_16x16x32_bf16 v[28:31], a[44:47], v[92:95], v[28:31]
  v_fma_f32 v0, v0, s24, -v116
  v_fma_f32 v1, v1, s24, -v116
  v_mfma_f32_16x16x32_bf16 v[32:35], a[64:67], v[80:83], 0
  v_exp_f32 v0, v0
  v_fma_f32 v2, v2, s24, -v116
  v_mfma_f32_16x16x32_bf16 v[32:35], a[68:71], v[84:87], v[32:35]
  v_fma_f32 v3, v3, s24, -v116
  v_exp_f32 v1, v1
  v_mfma_f32_16x16x32_bf16 v[32:35], a[72:75], v[88:91], v[32:35]
  s_add_u32 m0, s29, 42240
  s_mov_b32 s31, 73728
  buffer_load_dwordx4 v113, s[8:11], s31 offen offset:0 nt lds
  v_mfma_f32_16x16x32_bf16 v[32:35], a[76:79], v[92:95], v[32:35]
  v_exp_f32 v2, v2
  v_fma_f32 v4, v4, s24, -v116
  v_mfma_f32_16x16x32_bf16 v[36:39], a[96:99], v[80:83], 0
  v_cvt_pk_bf16_f32 v0, v0, v1
  v_exp_f32 v3, v3
  v_mfma_f32_16x16x32_bf16 v[36:39], a[100:103], v[84:87], v[36:39]
  v_fma_f32 v5, v5, s24, -v116
  v_fma_f32 v6, v6, s24, -v116
  v_mfma_f32_16x16x32_bf16 v[36:39], a[104:107], v[88:91], v[36:39]
  v_exp_f32 v4, v4
  v_fma_f32 v7, v7, s24, -v116
  v_mfma_f32_16x16x32_bf16 v[36:39], a[108:111], v[92:95], v[36:39]
  v_cvt_pk_bf16_f32 v1, v2, v3
  v_exp_f32 v5, v5
  v_mfma_f32_16x16x32_bf16 v[40:43], a[128:131], v[80:83], 0
  s_add_u32 m0, s29, 42272
  s_mov_b32 s31, 73728
  buffer_load_dwordx4 v113, s[8:11], s31 offen offset:1024 nt lds
  v_exp_f32 v6, v6
  v_mfma_f32_16x16x32_bf16 v[40:43], a[132:135], v[84:87], v[40:43]
  v_exp_f32 v7, v7
  v_cvt_pk_bf16_f32 v2, v4, v5
  v_mfma_f32_16x16x32_bf16 v[40:43], a[136:139], v[88:91], v[40:43]
  v_cvt_pk_bf16_f32 v3, v6, v7
  v_fma_f32 v8, v8, s24, -v116
  v_fma_f32 v9, v9, s24, -v116
  v_mfma_f32_16x16x32_bf16 v[40:43], a[140:143], v[92:95], v[40:43]
  v_exp_f32 v8, v8
  v_fma_f32 v10, v10, s24, -v116
  v_mfma_f32_16x16x32_bf16 v[44:47], a[160:163], v[80:83], 0
  ds_write_b128 v110, v[0:3] offset:16896
  v_mfma_f32_16x16x32_bf16 v[44:47], a[164:167], v[84:87], v[44:47]
  v_fma_f32 v11, v11, s24, -v116
  v_exp_f32 v9, v9
  v_mfma_f32_16x16x32_bf16 v[100:103], v[96:99], v[0:3], 0
  v_exp_f32 v10, v10
  v_fma_f32 v12, v12, s24, -v116
  v_mfma_f32_16x16x32_bf16 v[44:47], a[168:171], v[88:91], v[44:47]
  s_add_u32 m0, s29, 50688
  s_mov_b32 s31, 81920
  buffer_load_dwordx4 v113, s[8:11], s31 offen offset:0 nt lds
  v_mfma_f32_16x16x32_bf16 v[44:47], a[172:175], v[92:95], v[44:47]
  v_cvt_pk_bf16_f32 v8, v8, v9
  v_exp_f32 v11, v11
  s_waitcnt lgkmcnt(1)
  v_mfma_f32_16x16x32_bf16 v[24:27], a[16:19], v[64:67], v[24:27]
  s_add_u32 s33, s28, 16896
  s_cmp_eq_u32 s33, 67584
  s_cselect_b32 s33, 0, s33
  v_mfma_f32_16x16x32_bf16 v[24:27], a[20:23], v[68:71], v[24:27]
  v_fma_f32 v13, v13, s24, -v116
  v_fma_f32 v14, v14, s24, -v116
  s_sub_u32 s37, s33, s28
  v_mfma_f32_16x16x32_bf16 v[24:27], a[24:27], v[72:75], v[24:27]
  v_exp_f32 v12, v12
  s_add_u32 s35, s29, s28
  s_mov_b32 s28, s33
  v_fma_f32 v15, v15, s24, -v116
  v_add_u32 v108, s37, v108
  v_mfma_f32_16x16x32_bf16 v[24:27], a[28:31], v[76:79], v[24:27]
  v_cvt_pk_bf16_f32 v9, v10, v11
  v_exp_f32 v13, v13
  v_mfma_f32_16x16x32_bf16 v[28:31], a[48:51], v[64:67], v[28:31]
  s_add_u32 m0, s29, 50720
  s_mov_b32 s31, 81920
  buffer_load_dwordx4 v113, s[8:11], s31 offen offset:1024 nt lds
  v_exp_f32 v14, v14
  v_exp_f32 v15, v15
  v_mfma_f32_16x16x32_bf16 v[28:31], a[52:55], v[68:71], v[28:31]
  v_cvt_pk_bf16_f32 v10, v12, v13
  v_cvt_pk_bf16_f32 v11, v14, v15
  v_fma_f32 v16, v16, s24, -v116
  v_mfma_f32_16x16x32_bf16 v[28:31], a[56:59], v[72:75], v[28:31]
  v_fma_f32 v17, v17, s24, -v116
  v_exp_f32 v16, v16
  v_mfma_f32_16x16x32_bf16 v[28:31], a[60:63], v[76:79], v[28:31]
  v_fma_f32 v18, v18, s24, -v116
  ds_read_b128 v[80:83], v108 offset:0
  ds_read_b128 v[84:87], v108 offset:64
  ds_write_b128 v110, v[8:11] offset:17920
  v_mfma_f32_16x16x32_bf16 v[32:35], a[80:83], v[64:67], v[32:35]
  v_fma_f32 v19, v19, s24, -v116
  v_exp_f32 v17, v17
  v_mfma_f32_16x16x32_bf16 v[100:103], v[96:99], v[8:11], v[100:103]
  v_exp_f32 v18, v18
  v_fma_f32 v20, v20, s24, -v116
  v_mfma_f32_16x16x32_bf16 v[32:35], a[84:87], v[68:71], v[32:35]
  v_cvt_pk_bf16_f32 v16, v16, v17
  v_exp_f32 v19, v19
  v_mfma_f32_16x16x32_bf16 v[32:35], a[88:91], v[72:75], v[32:35]
  ds_read_b128 v[88:91], v108 offset:128
  ds_read_b128 v[92:95], v108 offset:192
  v_fma_f32 v21, v21, s24, -v116
  v_mfma_f32_16x16x32_bf16 v[32:35], a[92:95], v[76:79], v[32:35]
  v_fma_f32 v22, v22, s24, -v116
  v_exp_f32 v20, v20
  v_mfma_f32_16x16x32_bf16 v[36:39], a[112:115], v[64:67], v[36:39]
  v_fma_f32 v23, v23, s24, -v116
  v_cvt_pk_bf16_f32 v17, v18, v19
  v_max3_f32 v115, v24, v25, v26
  v_mfma_f32_16x16x32_bf16 v[36:39], a[116:119], v[68:71], v[36:39]
  v_exp_f32 v21, v21
  v_max3_f32 v115, v115, v27, v28
  v_mfma_f32_16x16x32_bf16 v[36:39], a[120:123], v[72:75], v[36:39]
  v_exp_f32 v22, v22
  v_max3_f32 v115, v115, v29, v30
  v_mfma_f32_16x16x32_bf16 v[36:39], a[124:127], v[76:79], v[36:39]
  v_exp_f32 v23, v23
  v_cvt_pk_bf16_f32 v18, v20, v21
  v_mfma_f32_16x16x32_bf16 v[40:43], a[144:147], v[64:67], v[40:43]
  v_cvt_pk_bf16_f32 v19, v22, v23
  v_rcp_f32 v118, v117
  v_mfma_f32_16x16x32_bf16 v[40:43], a[148:151], v[68:71], v[40:43]
  s_nop 0
  v_mov_b32_dpp v126, v118 row_ror:8 row_mask:0xf bank_mask:0xf
  v_max3_f32 v115, v115, v31, v32
  v_max3_f32 v115, v115, v33, v34
  v_mfma_f32_16x16x32_bf16 v[40:43], a[152:155], v[72:75], v[40:43]
  v_mfma_f32_16x16x32_bf16 v[100:103], v[96:99], v[16:19], v[100:103]
  ds_write_b128 v110, v[16:19] offset:18944
  v_mfma_f32_16x16x32_bf16 v[40:43], a[156:159], v[76:79], v[40:43]
  v_max3_f32 v115, v115, v35, v36
  v_max3_f32 v115, v115, v37, v38
  v_mfma_f32_16x16x32_bf16 v[44:47], a[176:179], v[64:67], v[44:47]
  s_mov_b32 s26, 90112
  s_mov_b32 s27, 24576
  s_add_u32 s30, s29, 50688
  v_mfma_f32_16x16x32_bf16 v[44:47], a[180:183], v[68:71], v[44:47]
  v_mfma_f32_16x16x32_bf16 v[44:47], a[184:187], v[72:75], v[44:47]
  ds_write_b32 v112, v100 offset:512
  v_mfma_f32_16x16x32_bf16 v[44:47], a[188:191], v[76:79], v[44:47]
  v_max3_f32 v115, v115, v39, v40
  v_max3_f32 v115, v115, v41, v42
  s_nop 5
  v_max3_f32 v115, v115, v43, v44
  v_max3_f32 v115, v115, v45, v46
  v_max_f32 v115, v115, v47
  ds_write_b32 v112, v115 offset:256
  ds_max_f32 v112, v115 offset:256
  s_waitcnt vmcnt(12) lgkmcnt(0)
  s_barrier
  .p2align 3
  L_loop:
  v_mfma_f32_16x16x32_bf16 v[0:3], a[0:3], v[80:83], 0
  ds_read_b128 v[104:107], v111 offset:256
  ds_read_b128 v[100:103], v111 offset:512
  v_mfma_f32_16x16x32_bf16 v[0:3], a[4:7], v[84:87], v[0:3]
  ds_read_b128 v[64:67], v108 offset:256
  ds_read_b128 v[68:71], v108 offset:320
  v_mfma_f32_16x16x32_bf16 v[0:3], a[8:11], v[88:91], v[0:3]
  ds_read_b128 v[72:75], v108 offset:384
  s_add_u32 m0, s30, 8448
  v_mfma_f32_16x16x32_bf16 v[0:3], a[12:15], v[92:95], v[0:3]
  buffer_load_dwordx4 v113, s[8:11], s26 offen offset:0 nt lds
  v_mfma_f32_16x16x32_bf16 v[4:7], a[32:35], v[80:83], 0
  ds_read_b128 v[76:79], v108 offset:448
  s_add_u32 m0, s30, 8480
  v_mfma_f32_16x16x32_bf16 v[4:7], a[36:39], v[84:87], v[4:7]
  buffer_load_dwordx4 v113, s[8:11], s26 offen offset:1024 nt lds
  v_mfma_f32_16x16x32_bf16 v[4:7], a[40:43], v[88:91], v[4:7]
  v_mul_f32 v48, v118, v48
  v_mul_f32 v49, v118, v49
  v_mfma_f32_16x16x32_bf16 v[4:7], a[44:47], v[92:95], v[4:7]
  v_mul_f32 v50, v118, v50
  v_mul_f32 v51, v118, v51
  v_mfma_f32_16x16x32_bf16 v[8:11], a[64:67], v[80:83], 0
  v_cvt_pk_bf16_f32 v48, v48, v49
  v_mul_f32 v52, v118, v52
  v_mfma_f32_16x16x32_bf16 v[8:11], a[68:71], v[84:87], v[8:11]
  v_mul_f32 v53, v118, v53
  v_cvt_pk_bf16_f32 v49, v50, v51
  v_mfma_f32_16x16x32_bf16 v[8:11], a[72:75], v[88:91], v[8:11]
  v_mul_f32 v54, v118, v54
  v_mul_f32 v55, v118, v55
  v_mfma_f32_16x16x32_bf16 v[8:11], a[76:79], v[92:95], v[8:11]
  v_cvt_pk_bf16_f32 v50, v52, v53
  v_cvt_pk_bf16_f32 v51, v54, v55
  v_mfma_f32_16x16x32_bf16 v[12:15], a[96:99], v[80:83], 0
  v_mul_f32_dpp v56, v56, v126 row_ror:8 row_mask:0xf bank_mask:0xf
  v_mul_f32_dpp v57, v57, v126 row_ror:8 row_mask:0xf bank_mask:0xf
  v_mfma_f32_16x16x32_bf16 v[12:15], a[100:103], v[84:87], v[12:15]
  v_mul_f32_dpp v58, v58, v126 row_ror:8 row_mask:0xf bank_mask:0xf
  v_mul_f32_dpp v59, v59, v126 row_ror:8 row_mask:0xf bank_mask:0xf
  v_mfma_f32_16x16x32_bf16 v[12:15], a[104:107], v[88:91], v[12:15]
  v_cvt_pk_bf16_f32 v56, v56, v57
  v_mul_f32_dpp v60, v60, v126 row_ror:8 row_mask:0xf bank_mask:0xf
  v_mfma_f32_16x16x32_bf16 v[12:15], a[108:111], v[92:95], v[12:15]
  v_mul_f32_dpp v61, v61, v126 row_ror:8 row_mask:0xf bank_mask:0xf
  s_waitcnt lgkmcnt(5)
  v_max3_f32 v116, v104, v105, v106
  v_mfma_f32_16x16x32_bf16 v[16:19], a[128:131], v[80:83], 0
  v_cvt_pk_bf16_f32 v57, v58, v59
  v_max_f32 v116, v116, v107
  v_mfma_f32_16x16x32_bf16 v[16:19], a[132:135], v[84:87], v[16:19]
  v_mul_f32_dpp v62, v62, v126 row_ror:8 row_mask:0xf bank_mask:0xf
  v_mul_f32 v116, s24, v116
  v_mfma_f32_16x16x32_bf16 v[16:19], a[136:139], v[88:91], v[16:19]
  v_mul_f32_dpp v63, v63, v126 row_ror:8 row_mask:0xf bank_mask:0xf
  s_waitcnt lgkmcnt(4)
  v_add_f32 v100, v100, v101
  v_mfma_f32_16x16x32_bf16 v[16:19], a[140:143], v[92:95], v[16:19]
  v_cvt_pk_bf16_f32 v58, v60, v61
  v_add_f32 v102, v102, v103
  v_mfma_f32_16x16x32_bf16 v[20:23], a[160:163], v[80:83], 0
  v_cvt_pk_bf16_f32 v59, v62, v63
  v_add_f32 v117, v100, v102
  v_mfma_f32_16x16x32_bf16 v[20:23], a[164:167], v[84:87], v[20:23]
  v_cndmask_b32_e64 v52, v48, v56, s[88:89]
  v_fma_f32 v24, v24, s24, -v116
  v_mfma_f32_16x16x32_bf16 v[20:23], a[168:171], v[88:91], v[20:23]
  v_cndmask_b32_e64 v53, v49, v57, s[88:89]
  v_fma_f32 v25, v25, s24, -v116
  v_mfma_f32_16x16x32_bf16 v[20:23], a[172:175], v[92:95], v[20:23]
  v_cndmask_b32_e64 v54, v50, v58, s[88:89]
  v_cndmask_b32_e64 v55, v51, v59, s[88:89]
  s_waitcnt lgkmcnt(0)
  v_mfma_f32_16x16x32_bf16 v[0:3], a[16:19], v[64:67], v[0:3]
  v_exp_f32 v24, v24
  v_mfma_f32_16x16x32_bf16 v[0:3], a[20:23], v[68:71], v[0:3]
  ds_read_b128 v[80:83], v109 offset:16896
  ds_read_b128 v[84:87], v109 offset:17920
  v_mfma_f32_16x16x32_bf16 v[0:3], a[24:27], v[72:75], v[0:3]
  ds_read_b128 v[88:91], v109 offset:18944
  ds_read_b128 v[92:95], v109 offset:19968
  v_mfma_f32_16x16x32_bf16 v[0:3], a[28:31], v[76:79], v[0:3]
  v_cndmask_b32_e64 v60, v56, v48, s[88:89]
  v_fma_f32 v26, v26, s24, -v116
  v_mfma_f32_16x16x32_bf16 v[4:7], a[48:51], v[64:67], v[4:7]
  v_cndmask_b32_e64 v61, v57, v49, s[88:89]
  v_fma_f32 v27, v27, s24, -v116
  v_mfma_f32_16x16x32_bf16 v[4:7], a[52:55], v[68:71], v[4:7]
  v_cndmask_b32_e64 v62, v58, v50, s[88:89]
  v_cndmask_b32_e64 v63, v59, v51, s[88:89]
  v_mfma_f32_16x16x32_bf16 v[4:7], a[56:59], v[72:75], v[4:7]
  v_exp_f32 v25, v25
  v_mfma_f32_16x16x32_bf16 v[4:7], a[60:63], v[76:79], v[4:7]
  buffer_store_dwordx4 v[52:55], v114, s[20:23], s27 offen offset:0 sc1
  v_mfma_f32_16x16x32_bf16 v[8:11], a[80:83], v[64:67], v[8:11]
  v_exp_f32 v26, v26
  v_mfma_f32_16x16x32_bf16 v[8:11], a[84:87], v[68:71], v[8:11]
  v_fma_f32 v28, v28, s24, -v116
  v_cvt_pk_bf16_f32 v24, v24, v25
  v_mfma_f32_16x16x32_bf16 v[8:11], a[88:91], v[72:75], v[8:11]
  v_exp_f32 v27, v27
  v_mfma_f32_16x16x32_bf16 v[8:11], a[92:95], v[76:79], v[8:11]
  buffer_store_dwordx4 v[60:63], v127, s[20:23], s27 offen offset:0 sc1
  v_mfma_f32_16x16x32_bf16 v[12:15], a[112:115], v[64:67], v[12:15]
  s_add_u32 s27, s27, 8192
  v_fma_f32 v29, v29, s24, -v116
  v_mfma_f32_16x16x32_bf16 v[12:15], a[116:119], v[68:71], v[12:15]
  v_fma_f32 v30, v30, s24, -v116
  v_max3_f32 v115, v0, v1, v2
  v_mfma_f32_16x16x32_bf16 v[12:15], a[120:123], v[72:75], v[12:15]
  v_exp_f32 v28, v28
  v_mfma_f32_16x16x32_bf16 v[12:15], a[124:127], v[76:79], v[12:15]
  v_fma_f32 v31, v31, s24, -v116
  v_cvt_pk_bf16_f32 v25, v26, v27
  v_mfma_f32_16x16x32_bf16 v[16:19], a[144:147], v[64:67], v[16:19]
  v_exp_f32 v29, v29
  v_mfma_f32_16x16x32_bf16 v[16:19], a[148:151], v[68:71], v[16:19]
  v_exp_f32 v30, v30
  v_mfma_f32_16x16x32_bf16 v[16:19], a[152:155], v[72:75], v[16:19]
  v_exp_f32 v31, v31
  v_mfma_f32_16x16x32_bf16 v[16:19], a[156:159], v[76:79], v[16:19]
  v_cvt_pk_bf16_f32 v26, v28, v29
  v_cvt_pk_bf16_f32 v27, v30, v31
  v_mfma_f32_16x16x32_bf16 v[20:23], a[176:179], v[64:67], v[20:23]
  v_fma_f32 v32, v32, s24, -v116
  v_fma_f32 v33, v33, s24, -v116
  v_mfma_f32_16x16x32_bf16 v[20:23], a[180:183], v[68:71], v[20:23]
  v_rcp_f32 v118, v117
  v_mfma_f32_16x16x32_bf16 v[20:23], a[184:187], v[72:75], v[20:23]
  s_nop 0
  v_mov_b32_dpp v126, v118 row_ror:8 row_mask:0xf bank_mask:0xf
  v_max3_f32 v115, v115, v3, v4
  v_mfma_f32_16x16x32_bf16 v[20:23], a[188:191], v[76:79], v[20:23]
  v_exp_f32 v32, v32
  s_waitcnt lgkmcnt(0)
  v_mfma_f32_16x16x32_bf16 v[48:51], a[192:195], v[80:83], 0
  v_fma_f32 v34, v34, s24, -v116
  v_max3_f32 v115, v115, v5, v6
  v_mfma_f32_16x16x32_bf16 v[48:51], a[208:211], v[84:87], v[48:51]
  ds_read_b128 v[64:67], v109 offset:20992
  ds_read_b128 v[68:71], v109 offset:22016
  v_mfma_f32_16x16x32_bf16 v[48:51], a[224:227], v[88:91], v[48:51]
  ds_read_b128 v[72:75], v109 offset:23040
  ds_read_b128 v[76:79], v109 offset:24064
  v_mfma_f32_16x16x32_bf16 v[48:51], a[240:243], v[92:95], v[48:51]
  ds_write_b128 v110, v[24:27] offset:29184
  v_mfma_f32_16x16x32_bf16 v[52:55], a[196:199], v[80:83], 0
  v_fma_f32 v35, v35, s24, -v116
  v_max3_f32 v115, v115, v7, v8
  v_mfma_f32_16x16x32_bf16 v[52:55], a[212:215], v[84:87], v[52:55]
  v_exp_f32 v33, v33
  v_mfma_f32_16x16x32_bf16 v[100:103], v[96:99], v[24:27], 0
  v_exp_f32 v34, v34
  v_mfma_f32_16x16x32_bf16 v[52:55], a[228:231], v[88:91], v[52:55]
  v_fma_f32 v36, v36, s24, -v116
  v_cvt_pk_bf16_f32 v32, v32, v33
  v_mfma_f32_16x16x32_bf16 v[52:55], a[244:247], v[92:95], v[52:55]
  v_exp_f32 v35, v35
  v_mfma_f32_16x16x32_bf16 v[56:59], a[200:203], v[80:83], 0
  v_fma_f32 v37, v37, s24, -v116
  v_fma_f32 v38, v38, s24, -v116
  v_mfma_f32_16x16x32_bf16 v[56:59], a[216:219], v[84:87], v[56:59]
  v_exp_f32 v36, v36
  v_mfma_f32_16x16x32_bf16 v[56:59], a[232:235], v[88:91], v[56:59]
  v_fma_f32 v39, v39, s24, -v116
  v_cvt_pk_bf16_f32 v33, v34, v35
  v_mfma_f32_16x16x32_bf16 v[56:59], a[248:251], v[92:95], v[56:59]
  v_exp_f32 v37, v37
  v_mfma_f32_16x16x32_bf16 v[60:63], a[204:207], v[80:83], 0
  v_exp_f32 v38, v38
  v_mfma_f32_16x16x32_bf16 v[60:63], a[220:223], v[84:87], v[60:63]
  v_exp_f32 v39, v39
  v_mfma_f32_16x16x32_bf16 v[60:63], a[236:239], v[88:91], v[60:63]
  v_cvt_pk_bf16_f32 v34, v36, v37
  v_cvt_pk_bf16_f32 v35, v38, v39
  v_mfma_f32_16x16x32_bf16 v[60:63], a[252:255], v[92:95], v[60:63]
  v_fma_f32 v40, v40, s24, -v116
  v_fma_f32 v41, v41, s24, -v116
  s_waitcnt lgkmcnt(1)
  v_mfma_f32_16x16x32_bf16 v[48:51], v[128:131], v[64:67], v[48:51]
  v_exp_f32 v40, v40
  v_mfma_f32_16x16x32_bf16 v[48:51], v[144:147], v[68:71], v[48:51]
  ds_read_b128 v[80:83], v109 offset:25088
  ds_read_b128 v[84:87], v109 offset:26112
  v_mfma_f32_16x16x32_bf16 v[48:51], v[160:163], v[72:75], v[48:51]
  ds_read_b128 v[88:91], v109 offset:27136
  ds_read_b128 v[92:95], v109 offset:28160
  v_mfma_f32_16x16x32_bf16 v[48:51], v[176:179], v[76:79], v[48:51]
  v_fma_f32 v42, v42, s24, -v116
  v_max3_f32 v115, v115, v9, v10
  v_mfma_f32_16x16x32_bf16 v[52:55], v[132:135], v[64:67], v[52:55]
  ds_write_b128 v110, v[32:35] offset:30208
  v_mfma_f32_16x16x32_bf16 v[52:55], v[148:151], v[68:71], v[52:55]
  v_fma_f32 v43, v43, s24, -v116
  v_max3_f32 v115, v115, v11, v12
  v_mfma_f32_16x16x32_bf16 v[52:55], v[164:167], v[72:75], v[52:55]
  v_exp_f32 v41, v41
  v_mfma_f32_16x16x32_bf16 v[100:103], v[96:99], v[32:35], v[100:103]
  v_exp_f32 v42, v42
  v_mfma_f32_16x16x32_bf16 v[52:55], v[180:183], v[76:79], v[52:55]
  v_fma_f32 v44, v44, s24, -v116
  v_cvt_pk_bf16_f32 v40, v40, v41
  v_mfma_f32_16x16x32_bf16 v[56:59], v[136:139], v[64:67], v[56:59]
  v_exp_f32 v43, v43
  v_mfma_f32_16x16x32_bf16 v[56:59], v[152:155], v[68:71], v[56:59]
  v_fma_f32 v45, v45, s24, -v116
  v_fma_f32 v46, v46, s24, -v116
  v_mfma_f32_16x16x32_bf16 v[56:59], v[168:171], v[72:75], v[56:59]
  v_exp_f32 v44, v44
  v_mfma_f32_16x16x32_bf16 v[56:59], v[184:187], v[76:79], v[56:59]
  v_fma_f32 v47, v47, s24, -v116
  v_cvt_pk_bf16_f32 v41, v42, v43
  v_mfma_f32_16x16x32_bf16 v[60:63], v[140:143], v[64:67], v[60:63]
  v_exp_f32 v45, v45
  v_mfma_f32_16x16x32_bf16 v[60:63], v[156:159], v[68:71], v[60:63]
  v_exp_f32 v46, v46
  v_mfma_f32_16x16x32_bf16 v[60:63], v[172:175], v[72:75], v[60:63]
  v_exp_f32 v47, v47
  v_mfma_f32_16x16x32_bf16 v[60:63], v[188:191], v[76:79], v[60:63]
  v_cvt_pk_bf16_f32 v42, v44, v45
  v_max3_f32 v115, v115, v13, v14
  s_waitcnt lgkmcnt(1)
  v_mfma_f32_16x16x32_bf16 v[48:51], v[192:195], v[80:83], v[48:51]
  v_cvt_pk_bf16_f32 v43, v46, v47
  v_max3_f32 v115, v115, v15, v16
  v_mfma_f32_16x16x32_bf16 v[48:51], v[208:211], v[84:87], v[48:51]
  ds_read_b128 v[64:67], v108 offset:8448
  ds_read_b128 v[68:71], v108 offset:8512
  v_mfma_f32_16x16x32_bf16 v[48:51], v[224:227], v[88:91], v[48:51]
  ds_read_b128 v[72:75], v108 offset:8576
  v_max3_f32 v115, v115, v17, v18
  v_mfma_f32_16x16x32_bf16 v[100:103], v[96:99], v[40:43], v[100:103]
  ds_read_b128 v[76:79], v108 offset:8640
  v_max3_f32 v115, v115, v19, v20
  v_mfma_f32_16x16x32_bf16 v[48:51], v[240:243], v[92:95], v[48:51]
  ds_write_b128 v110, v[40:43] offset:31232
  v_mfma_f32_16x16x32_bf16 v[52:55], v[196:199], v[80:83], v[52:55]
  v_max3_f32 v115, v115, v21, v22
  v_max_f32 v115, v115, v23
  v_mfma_f32_16x16x32_bf16 v[52:55], v[212:215], v[84:87], v[52:55]
  s_add_u32 s26, s26, 8192
  v_mfma_f32_16x16x32_bf16 v[52:55], v[228:231], v[88:91], v[52:55]
  ds_write_b32 v112, v115 offset:0
  v_mfma_f32_16x16x32_bf16 v[52:55], v[244:247], v[92:95], v[52:55]
  ds_write_b32 v112, v100 offset:768
  v_mfma_f32_16x16x32_bf16 v[56:59], v[200:203], v[80:83], v[56:59]
  ds_max_f32 v112, v115 offset:0
  v_mfma_f32_16x16x32_bf16 v[56:59], v[216:219], v[84:87], v[56:59]
  v_mfma_f32_16x16x32_bf16 v[56:59], v[232:235], v[88:91], v[56:59]
  v_mfma_f32_16x16x32_bf16 v[56:59], v[248:251], v[92:95], v[56:59]
  v_mfma_f32_16x16x32_bf16 v[60:63], v[204:207], v[80:83], v[60:63]
  v_mfma_f32_16x16x32_bf16 v[60:63], v[220:223], v[84:87], v[60:63]
  v_mfma_f32_16x16x32_bf16 v[60:63], v[236:239], v[88:91], v[60:63]
  v_mfma_f32_16x16x32_bf16 v[60:63], v[252:255], v[92:95], v[60:63]
  s_waitcnt vmcnt(10) lgkmcnt(0)
  s_barrier
  v_mfma_f32_16x16x32_bf16 v[24:27], a[0:3], v[64:67], 0
  ds_read_b128 v[104:107], v111 offset:0
  ds_read_b128 v[100:103], v111 offset:768
  v_mfma_f32_16x16x32_bf16 v[24:27], a[4:7], v[68:71], v[24:27]
  s_mov_b32 s30, s35
  ds_read_b128 v[80:83], v108 offset:8704
  v_mfma_f32_16x16x32_bf16 v[24:27], a[8:11], v[72:75], v[24:27]
  ds_read_b128 v[84:87], v108 offset:8768
  s_mov_b32 m0, s30
  v_mfma_f32_16x16x32_bf16 v[24:27], a[12:15], v[76:79], v[24:27]
  buffer_load_dwordx4 v113, s[8:11], s26 offen offset:0 nt lds
  v_mfma_f32_16x16x32_bf16 v[28:31], a[32:35], v[64:67], 0
  ds_read_b128 v[88:91], v108 offset:8832
  s_add_u32 m0, s30, 32
  v_mfma_f32_16x16x32_bf16 v[28:31], a[36:39], v[68:71], v[28:31]
  buffer_load_dwordx4 v113, s[8:11], s26 offen offset:1024 nt lds
  v_mfma_f32_16x16x32_bf16 v[28:31], a[40:43], v[72:75], v[28:31]
  ds_read_b128 v[92:95], v108 offset:8896
  v_mul_f32 v48, v118, v48
  v_mfma_f32_16x16x32_bf16 v[28:31], a[44:47], v[76:79], v[28:31]
  v_mul_f32 v49, v118, v49
  v_mul_f32 v50, v118, v50
  v_mfma_f32_16x16x32_bf16 v[32:35], a[64:67], v[64:67], 0
  v_mul_f32 v51, v118, v51
  v_cvt_pk_bf16_f32 v48, v48, v49
  v_mfma_f32_16x16x32_bf16 v[32:35], a[68:71], v[68:71], v[32:35]
  v_mul_f32 v52, v118, v52
  v_mul_f32 v53, v118, v53
  v_mfma_f32_16x16x32_bf16 v[32:35], a[72:75], v[72:75], v[32:35]
  v_cvt_pk_bf16_f32 v49, v50, v51
  v_mul_f32 v54, v118, v54
  v_mfma_f32_16x16x32_bf16 v[32:35], a[76:79], v[76:79], v[32:35]
  v_mul_f32 v55, v118, v55
  v_cvt_pk_bf16_f32 v50, v52, v53
  v_mfma_f32_16x16x32_bf16 v[36:39], a[96:99], v[64:67], 0
  v_cvt_pk_bf16_f32 v51, v54, v55
  v_mul_f32_dpp v56, v56, v126 row_ror:8 row_mask:0xf bank_mask:0xf
  v_mfma_f32_16x16x32_bf16 v[36:39], a[100:103], v[68:71], v[36:39]
  v_mul_f32_dpp v57, v57, v126 row_ror:8 row_mask:0xf bank_mask:0xf
  v_mul_f32_dpp v58, v58, v126 row_ror:8 row_mask:0xf bank_mask:0xf
  v_mfma_f32_16x16x32_bf16 v[36:39], a[104:107], v[72:75], v[36:39]
  v_mul_f32_dpp v59, v59, v126 row_ror:8 row_mask:0xf bank_mask:0xf
  v_cvt_pk_bf16_f32 v56, v56, v57
  v_mfma_f32_16x16x32_bf16 v[36:39], a[108:111], v[76:79], v[36:39]
  v_mul_f32_dpp v60, v60, v126 row_ror:8 row_mask:0xf bank_mask:0xf
  v_mul_f32_dpp v61, v61, v126 row_ror:8 row_mask:0xf bank_mask:0xf
  v_mfma_f32_16x16x32_bf16 v[40:43], a[128:131], v[64:67], 0
  s_waitcnt lgkmcnt(5)
  v_max3_f32 v116, v104, v105, v106
  v_cvt_pk_bf16_f32 v57, v58, v59
  v_mfma_f32_16x16x32_bf16 v[40:43], a[132:135], v[68:71], v[40:43]
  v_max_f32 v116, v116, v107
  v_mul_f32_dpp v62, v62, v126 row_ror:8 row_mask:0xf bank_mask:0xf
  v_mfma_f32_16x16x32_bf16 v[40:43], a[136:139], v[72:75], v[40:43]
  v_mul_f32 v116, s24, v116
  v_mul_f32_dpp v63, v63, v126 row_ror:8 row_mask:0xf bank_mask:0xf
  v_mfma_f32_16x16x32_bf16 v[40:43], a[140:143], v[76:79], v[40:43]
  s_waitcnt lgkmcnt(4)
  v_add_f32 v100, v100, v101
  v_cvt_pk_bf16_f32 v58, v60, v61
  v_mfma_f32_16x16x32_bf16 v[44:47], a[160:163], v[64:67], 0
  v_add_f32 v102, v102, v103
  v_cvt_pk_bf16_f32 v59, v62, v63
  v_mfma_f32_16x16x32_bf16 v[44:47], a[164:167], v[68:71], v[44:47]
  v_add_f32 v117, v100, v102
  v_cndmask_b32_e64 v52, v48, v56, s[88:89]
  v_mfma_f32_16x16x32_bf16 v[44:47], a[168:171], v[72:75], v[44:47]
  v_fma_f32 v0, v0, s24, -v116
  v_cndmask_b32_e64 v53, v49, v57, s[88:89]
  v_mfma_f32_16x16x32_bf16 v[44:47], a[172:175], v[76:79], v[44:47]
  v_fma_f32 v1, v1, s24, -v116
  v_cndmask_b32_e64 v54, v50, v58, s[88:89]
  s_waitcnt lgkmcnt(0)
  v_mfma_f32_16x16x32_bf16 v[24:27], a[16:19], v[80:83], v[24:27]
  v_exp_f32 v0, v0
  v_mfma_f32_16x16x32_bf16 v[24:27], a[20:23], v[84:87], v[24:27]
  ds_read_b128 v[64:67], v109 offset:29184
  ds_read_b128 v[68:71], v109 offset:30208
  v_mfma_f32_16x16x32_bf16 v[24:27], a[24:27], v[88:91], v[24:27]
  ds_read_b128 v[72:75], v109 offset:31232
  ds_read_b128 v[76:79], v109 offset:32256
  v_mfma_f32_16x16x32_bf16 v[24:27], a[28:31], v[92:95], v[24:27]
  v_cndmask_b32_e64 v55, v51, v59, s[88:89]
  v_cndmask_b32_e64 v60, v56, v48, s[88:89]
  v_mfma_f32_16x16x32_bf16 v[28:31], a[48:51], v[80:83], v[28:31]
  v_fma_f32 v2, v2, s24, -v116
  v_cndmask_b32_e64 v61, v57, v49, s[88:89]
  v_mfma_f32_16x16x32_bf16 v[28:31], a[52:55], v[84:87], v[28:31]
  v_fma_f32 v3, v3, s24, -v116
  v_cndmask_b32_e64 v62, v58, v50, s[88:89]
  v_mfma_f32_16x16x32_bf16 v[28:31], a[56:59], v[88:91], v[28:31]
  v_exp_f32 v1, v1
  v_mfma_f32_16x16x32_bf16 v[28:31], a[60:63], v[92:95], v[28:31]
  v_cndmask_b32_e64 v63, v59, v51, s[88:89]
  s_add_u32 s33, s28, 16896
  v_mfma_f32_16x16x32_bf16 v[32:35], a[80:83], v[80:83], v[32:35]
  buffer_store_dwordx4 v[52:55], v114, s[20:23], s27 offen offset:0 sc1
  v_mfma_f32_16x16x32_bf16 v[32:35], a[84:87], v[84:87], v[32:35]
  v_exp_f32 v2, v2
  v_mfma_f32_16x16x32_bf16 v[32:35], a[88:91], v[88:91], v[32:35]
  v_fma_f32 v4, v4, s24, -v116
  v_cvt_pk_bf16_f32 v0, v0, v1
  v_mfma_f32_16x16x32_bf16 v[32:35], a[92:95], v[92:95], v[32:35]
  v_exp_f32 v3, v3
  v_mfma_f32_16x16x32_bf16 v[36:39], a[112:115], v[80:83], v[36:39]
  buffer_store_dwordx4 v[60:63], v127, s[20:23], s27 offen offset:0 sc1
  v_mfma_f32_16x16x32_bf16 v[36:39], a[116:119], v[84:87], v[36:39]
  s_add_u32 s27, s27, 8192
  v_fma_f32 v5, v5, s24, -v116
  v_mfma_f32_16x16x32_bf16 v[36:39], a[120:123], v[88:91], v[36:39]
  v_fma_f32 v6, v6, s24, -v116
  v_max3_f32 v115, v24, v25, v26
  v_mfma_f32_16x16x32_bf16 v[36:39], a[124:127], v[92:95], v[36:39]
  v_exp_f32 v4, v4
  v_mfma_f32_16x16x32_bf16 v[40:43], a[144:147], v[80:83], v[40:43]
  v_fma_f32 v7, v7, s24, -v116
  v_cvt_pk_bf16_f32 v1, v2, v3
  v_mfma_f32_16x16x32_bf16 v[40:43], a[148:151], v[84:87], v[40:43]
  v_exp_f32 v5, v5
  v_mfma_f32_16x16x32_bf16 v[40:43], a[152:155], v[88:91], v[40:43]
  v_exp_f32 v6, v6
  v_mfma_f32_16x16x32_bf16 v[40:43], a[156:159], v[92:95], v[40:43]
  v_exp_f32 v7, v7
  v_mfma_f32_16x16x32_bf16 v[44:47], a[176:179], v[80:83], v[44:47]
  v_cvt_pk_bf16_f32 v2, v4, v5
  v_cvt_pk_bf16_f32 v3, v6, v7
  v_mfma_f32_16x16x32_bf16 v[44:47], a[180:183], v[84:87], v[44:47]
  v_rcp_f32 v118, v117
  v_mfma_f32_16x16x32_bf16 v[44:47], a[184:187], v[88:91], v[44:47]
  s_nop 0
  v_mov_b32_dpp v126, v118 row_ror:8 row_mask:0xf bank_mask:0xf
  v_fma_f32 v8, v8, s24, -v116
  v_mfma_f32_16x16x32_bf16 v[44:47], a[188:191], v[92:95], v[44:47]
  v_fma_f32 v9, v9, s24, -v116
  v_max3_f32 v115, v115, v27, v28
  s_waitcnt lgkmcnt(0)
  v_mfma_f32_16x16x32_bf16 v[48:51], a[192:195], v[64:67], 0
  v_exp_f32 v8, v8
  v_mfma_f32_16x16x32_bf16 v[48:51], a[208:211], v[68:71], v[48:51]
  ds_read_b128 v[80:83], v109 offset:33280
  ds_read_b128 v[84:87], v109 offset:34304
  v_mfma_f32_16x16x32_bf16 v[48:51], a[224:227], v[72:75], v[48:51]
  ds_read_b128 v[88:91], v109 offset:35328
  v_fma_f32 v10, v10, s24, -v116
  v_mfma_f32_16x16x32_bf16 v[48:51], a[240:243], v[76:79], v[48:51]
  ds_read_b128 v[92:95], v109 offset:36352
  v_max3_f32 v115, v115, v29, v30
  v_mfma_f32_16x16x32_bf16 v[52:55], a[196:199], v[64:67], 0
  ds_write_b128 v110, v[0:3] offset:16896
  v_mfma_f32_16x16x32_bf16 v[52:55], a[212:215], v[68:71], v[52:55]
  v_fma_f32 v11, v11, s24, -v116
  v_max3_f32 v115, v115, v31, v32
  v_mfma_f32_16x16x32_bf16 v[52:55], a[228:231], v[72:75], v[52:55]
  v_exp_f32 v9, v9
  v_mfma_f32_16x16x32_bf16 v[100:103], v[96:99], v[0:3], 0
  v_exp_f32 v10, v10
  v_mfma_f32_16x16x32_bf16 v[52:55], a[244:247], v[76:79], v[52:55]
  v_fma_f32 v12, v12, s24, -v116
  v_cvt_pk_bf16_f32 v8, v8, v9
  v_mfma_f32_16x16x32_bf16 v[56:59], a[200:203], v[64:67], 0
  v_exp_f32 v11, v11
  v_mfma_f32_16x16x32_bf16 v[56:59], a[216:219], v[68:71], v[56:59]
  v_fma_f32 v13, v13, s24, -v116
  v_fma_f32 v14, v14, s24, -v116
  v_mfma_f32_16x16x32_bf16 v[56:59], a[232:235], v[72:75], v[56:59]
  v_exp_f32 v12, v12
  v_mfma_f32_16x16x32_bf16 v[56:59], a[248:251], v[76:79], v[56:59]
  v_fma_f32 v15, v15, s24, -v116
  v_cvt_pk_bf16_f32 v9, v10, v11
  v_mfma_f32_16x16x32_bf16 v[60:63], a[204:207], v[64:67], 0
  v_exp_f32 v13, v13
  v_mfma_f32_16x16x32_bf16 v[60:63], a[220:223], v[68:71], v[60:63]
  v_exp_f32 v14, v14
  v_mfma_f32_16x16x32_bf16 v[60:63], a[236:239], v[72:75], v[60:63]
  v_exp_f32 v15, v15
  v_mfma_f32_16x16x32_bf16 v[60:63], a[252:255], v[76:79], v[60:63]
  v_cvt_pk_bf16_f32 v10, v12, v13
  v_cvt_pk_bf16_f32 v11, v14, v15
  s_waitcnt lgkmcnt(1)
  v_mfma_f32_16x16x32_bf16 v[48:51], v[128:131], v[80:83], v[48:51]
  v_fma_f32 v16, v16, s24, -v116
  v_fma_f32 v17, v17, s24, -v116
  v_mfma_f32_16x16x32_bf16 v[48:51], v[144:147], v[84:87], v[48:51]
  ds_read_b128 v[64:67], v109 offset:37376
  ds_read_b128 v[68:71], v109 offset:38400
  v_mfma_f32_16x16x32_bf16 v[48:51], v[160:163], v[88:91], v[48:51]
  ds_read_b128 v[72:75], v109 offset:39424
  ds_read_b128 v[76:79], v109 offset:40448
  v_mfma_f32_16x16x32_bf16 v[48:51], v[176:179], v[92:95], v[48:51]
  v_exp_f32 v16, v16
  v_mfma_f32_16x16x32_bf16 v[52:55], v[132:135], v[80:83], v[52:55]
  v_fma_f32 v18, v18, s24, -v116
  v_max3_f32 v115, v115, v33, v34
  v_mfma_f32_16x16x32_bf16 v[52:55], v[148:151], v[84:87], v[52:55]
  ds_write_b128 v110, v[8:11] offset:17920
  v_mfma_f32_16x16x32_bf16 v[52:55], v[164:167], v[88:91], v[52:55]
  s_cmp_eq_u32 s33, 67584
  s_cselect_b32 s33, 0, s33
  v_mfma_f32_16x16x32_bf16 v[52:55], v[180:183], v[92:95], v[52:55]
  v_fma_f32 v19, v19, s24, -v116
  s_sub_u32 s37, s33, s28
  v_mfma_f32_16x16x32_bf16 v[56:59], v[136:139], v[80:83], v[56:59]
  v_exp_f32 v17, v17
  v_mfma_f32_16x16x32_bf16 v[100:103], v[96:99], v[8:11], v[100:103]
  s_add_u32 s35, s29, s28
  s_mov_b32 s28, s33
  v_mfma_f32_16x16x32_bf16 v[56:59], v[152:155], v[84:87], v[56:59]
  v_add_u32 v108, s37, v108
  v_max3_f32 v115, v115, v35, v36
  v_mfma_f32_16x16x32_bf16 v[56:59], v[168:171], v[88:91], v[56:59]
  v_exp_f32 v18, v18
  v_mfma_f32_16x16x32_bf16 v[56:59], v[184:187], v[92:95], v[56:59]
  v_fma_f32 v20, v20, s24, -v116
  v_cvt_pk_bf16_f32 v16, v16, v17
  v_mfma_f32_16x16x32_bf16 v[60:63], v[140:143], v[80:83], v[60:63]
  v_exp_f32 v19, v19
  v_mfma_f32_16x16x32_bf16 v[60:63], v[156:159], v[84:87], v[60:63]
  v_fma_f32 v21, v21, s24, -v116
  v_fma_f32 v22, v22, s24, -v116
  v_mfma_f32_16x16x32_bf16 v[60:63], v[172:175], v[88:91], v[60:63]
  v_exp_f32 v20, v20
  v_mfma_f32_16x16x32_bf16 v[60:63], v[188:191], v[92:95], v[60:63]
  v_fma_f32 v23, v23, s24, -v116
  v_cvt_pk_bf16_f32 v17, v18, v19
  s_waitcnt lgkmcnt(1)
  v_mfma_f32_16x16x32_bf16 v[48:51], v[192:195], v[64:67], v[48:51]
  v_exp_f32 v21, v21
  v_mfma_f32_16x16x32_bf16 v[48:51], v[208:211], v[68:71], v[48:51]
  v_exp_f32 v22, v22
  v_mfma_f32_16x16x32_bf16 v[48:51], v[224:227], v[72:75], v[48:51]
  v_exp_f32 v23, v23
  v_mfma_f32_16x16x32_bf16 v[48:51], v[240:243], v[76:79], v[48:51]
  ds_read_b128 v[80:83], v108 offset:0
  v_cvt_pk_bf16_f32 v18, v20, v21
  v_mfma_f32_16x16x32_bf16 v[52:55], v[196:199], v[64:67], v[52:55]
  v_max3_f32 v115, v115, v37, v38
  ds_read_b128 v[84:87], v108 offset:64
  v_mfma_f32_16x16x32_bf16 v[52:55], v[212:215], v[68:71], v[52:55]
  v_cvt_pk_bf16_f32 v19, v22, v23
  v_max3_f32 v115, v115, v39, v40
  v_mfma_f32_16x16x32_bf16 v[52:55], v[228:231], v[72:75], v[52:55]
  ds_read_b128 v[88:91], v108 offset:128
  v_max3_f32 v115, v115, v41, v42
  v_mfma_f32_16x16x32_bf16 v[52:55], v[244:247], v[76:79], v[52:55]
  v_mfma_f32_16x16x32_bf16 v[100:103], v[96:99], v[16:19], v[100:103]
  ds_read_b128 v[92:95], v108 offset:192
  v_max3_f32 v115, v115, v43, v44
  v_mfma_f32_16x16x32_bf16 v[56:59], v[200:203], v[64:67], v[56:59]
  ds_write_b128 v110, v[16:19] offset:18944
  v_max3_f32 v115, v115, v45, v46
  v_max_f32 v115, v115, v47
  v_mfma_f32_16x16x32_bf16 v[56:59], v[216:219], v[68:71], v[56:59]
  s_add_u32 s26, s26, 8192
  v_mfma_f32_16x16x32_bf16 v[56:59], v[232:235], v[72:75], v[56:59]
  ds_write_b32 v112, v115 offset:256
  v_mfma_f32_16x16x32_bf16 v[56:59], v[248:251], v[76:79], v[56:59]
  ds_max_f32 v112, v115 offset:256
  v_mfma_f32_16x16x32_bf16 v[60:63], v[204:207], v[64:67], v[60:63]
  ds_write_b32 v112, v100 offset:512
  v_mfma_f32_16x16x32_bf16 v[60:63], v[220:223], v[68:71], v[60:63]
  v_mfma_f32_16x16x32_bf16 v[60:63], v[236:239], v[72:75], v[60:63]
  v_mfma_f32_16x16x32_bf16 v[60:63], v[252:255], v[76:79], v[60:63]
  s_waitcnt vmcnt(10) lgkmcnt(0)
  s_cmp_lt_u32 s27, 172032
  s_barrier
  s_cbranch_scc1 L_loop
  ds_read_b128 v[80:83], v109 offset:16896
  ds_read_b128 v[84:87], v109 offset:17920
  ds_read_b128 v[88:91], v109 offset:18944
  ds_read_b128 v[92:95], v109 offset:19968
  ds_read_b128 v[104:107], v111 offset:256
  ds_read_b128 v[100:103], v111 offset:512
  v_mul_f32 v48, v118, v48
  v_mul_f32 v49, v118, v49
  v_mul_f32 v50, v118, v50
  v_mul_f32 v51, v118, v51
  v_cvt_pk_bf16_f32 v48, v48, v49
  v_mul_f32 v52, v118, v52
  v_mul_f32 v53, v118, v53
  v_cvt_pk_bf16_f32 v49, v50, v51
  s_waitcnt lgkmcnt(2)
  v_mfma_f32_16x16x32_bf16 v[0:3], a[192:195], v[80:83], 0
  s_waitcnt lgkmcnt(1)
  v_max3_f32 v116, v104, v105, v106
  v_max_f32 v116, v116, v107
  v_mul_f32 v116, s24, v116
  s_waitcnt lgkmcnt(0)
  v_add_f32 v100, v100, v101
  v_mfma_f32_16x16x32_bf16 v[0:3], a[208:211], v[84:87], v[0:3]
  v_add_f32 v102, v102, v103
  v_add_f32 v117, v100, v102
  v_fma_f32 v24, v24, s24, -v116
  v_fma_f32 v25, v25, s24, -v116
  v_mfma_f32_16x16x32_bf16 v[0:3], a[224:227], v[88:91], v[0:3]
  v_exp_f32 v24, v24
  v_fma_f32 v26, v26, s24, -v116
  v_fma_f32 v27, v27, s24, -v116
  v_mfma_f32_16x16x32_bf16 v[0:3], a[240:243], v[92:95], v[0:3]
  v_exp_f32 v25, v25
  ds_read_b128 v[64:67], v109 offset:20992
  ds_read_b128 v[68:71], v109 offset:22016
  v_mfma_f32_16x16x32_bf16 v[4:7], a[196:199], v[80:83], 0
  v_exp_f32 v26, v26
  ds_read_b128 v[72:75], v109 offset:23040
  v_fma_f32 v28, v28, s24, -v116
  v_mfma_f32_16x16x32_bf16 v[4:7], a[212:215], v[84:87], v[4:7]
  ds_read_b128 v[76:79], v109 offset:24064
  v_cvt_pk_bf16_f32 v24, v24, v25
  v_exp_f32 v27, v27
  v_mfma_f32_16x16x32_bf16 v[4:7], a[228:231], v[88:91], v[4:7]
  v_fma_f32 v29, v29, s24, -v116
  v_fma_f32 v30, v30, s24, -v116
  v_exp_f32 v28, v28
  v_mfma_f32_16x16x32_bf16 v[4:7], a[244:247], v[92:95], v[4:7]
  v_fma_f32 v31, v31, s24, -v116
  v_cvt_pk_bf16_f32 v25, v26, v27
  v_exp_f32 v29, v29
  v_mfma_f32_16x16x32_bf16 v[8:11], a[200:203], v[80:83], 0
  v_exp_f32 v30, v30
  v_exp_f32 v31, v31
  v_mfma_f32_16x16x32_bf16 v[8:11], a[216:219], v[84:87], v[8:11]
  v_cvt_pk_bf16_f32 v26, v28, v29
  v_cvt_pk_bf16_f32 v27, v30, v31
  v_fma_f32 v32, v32, s24, -v116
  v_fma_f32 v33, v33, s24, -v116
  v_mfma_f32_16x16x32_bf16 v[8:11], a[232:235], v[88:91], v[8:11]
  v_exp_f32 v32, v32
  v_fma_f32 v34, v34, s24, -v116
  v_mfma_f32_16x16x32_bf16 v[8:11], a[248:251], v[92:95], v[8:11]
  ds_write_b128 v110, v[24:27] offset:29184
  v_mfma_f32_16x16x32_bf16 v[12:15], a[204:207], v[80:83], 0
  v_fma_f32 v35, v35, s24, -v116
  v_exp_f32 v33, v33
  v_mfma_f32_16x16x32_bf16 v[12:15], a[220:223], v[84:87], v[12:15]
  v_mfma_f32_16x16x32_bf16 v[100:103], v[96:99], v[24:27], 0
  v_exp_f32 v34, v34
  v_fma_f32 v36, v36, s24, -v116
  v_cvt_pk_bf16_f32 v32, v32, v33
  v_mfma_f32_16x16x32_bf16 v[12:15], a[236:239], v[88:91], v[12:15]
  v_exp_f32 v35, v35
  v_fma_f32 v37, v37, s24, -v116
  v_fma_f32 v38, v38, s24, -v116
  v_mfma_f32_16x16x32_bf16 v[12:15], a[252:255], v[92:95], v[12:15]
  v_exp_f32 v36, v36
  v_fma_f32 v39, v39, s24, -v116
  v_cvt_pk_bf16_f32 v33, v34, v35
  s_waitcnt lgkmcnt(1)
  v_mfma_f32_16x16x32_bf16 v[0:3], v[128:131], v[64:67], v[0:3]
  v_exp_f32 v37, v37
  v_exp_f32 v38, v38
  v_mfma_f32_16x16x32_bf16 v[0:3], v[144:147], v[68:71], v[0:3]
  v_exp_f32 v39, v39
  v_cvt_pk_bf16_f32 v34, v36, v37
  v_cvt_pk_bf16_f32 v35, v38, v39
  v_mfma_f32_16x16x32_bf16 v[0:3], v[160:163], v[72:75], v[0:3]
  v_fma_f32 v40, v40, s24, -v116
  v_fma_f32 v41, v41, s24, -v116
  v_exp_f32 v40, v40
  v_mfma_f32_16x16x32_bf16 v[0:3], v[176:179], v[76:79], v[0:3]
  v_fma_f32 v42, v42, s24, -v116
  ds_read_b128 v[80:83], v109 offset:25088
  ds_read_b128 v[84:87], v109 offset:26112
  ds_read_b128 v[88:91], v109 offset:27136
  v_mfma_f32_16x16x32_bf16 v[4:7], v[132:135], v[64:67], v[4:7]
  ds_write_b128 v110, v[32:35] offset:30208
  v_mfma_f32_16x16x32_bf16 v[4:7], v[148:151], v[68:71], v[4:7]
  v_fma_f32 v43, v43, s24, -v116
  v_exp_f32 v41, v41
  ds_read_b128 v[92:95], v109 offset:28160
  v_mfma_f32_16x16x32_bf16 v[100:103], v[96:99], v[32:35], v[100:103]
  v_exp_f32 v42, v42
  v_fma_f32 v44, v44, s24, -v116
  v_cvt_pk_bf16_f32 v40, v40, v41
  v_mfma_f32_16x16x32_bf16 v[4:7], v[164:167], v[72:75], v[4:7]
  v_exp_f32 v43, v43
  v_fma_f32 v45, v45, s24, -v116
  v_fma_f32 v46, v46, s24, -v116
  v_mfma_f32_16x16x32_bf16 v[4:7], v[180:183], v[76:79], v[4:7]
  v_exp_f32 v44, v44
  v_fma_f32 v47, v47, s24, -v116
  v_cvt_pk_bf16_f32 v41, v42, v43
  v_mfma_f32_16x16x32_bf16 v[8:11], v[136:139], v[64:67], v[8:11]
  v_exp_f32 v45, v45
  v_exp_f32 v46, v46
  v_mfma_f32_16x16x32_bf16 v[8:11], v[152:155], v[68:71], v[8:11]
  v_exp_f32 v47, v47
  v_cvt_pk_bf16_f32 v42, v44, v45
  v_cvt_pk_bf16_f32 v43, v46, v47
  v_mfma_f32_16x16x32_bf16 v[8:11], v[168:171], v[72:75], v[8:11]
  v_mfma_f32_16x16x32_bf16 v[8:11], v[184:187], v[76:79], v[8:11]
  v_mfma_f32_16x16x32_bf16 v[100:103], v[96:99], v[40:43], v[100:103]
  ds_write_b128 v110, v[40:43] offset:31232
  v_mfma_f32_16x16x32_bf16 v[12:15], v[140:143], v[64:67], v[12:15]
  v_mfma_f32_16x16x32_bf16 v[12:15], v[156:159], v[68:71], v[12:15]
  v_mfma_f32_16x16x32_bf16 v[12:15], v[172:175], v[72:75], v[12:15]
  v_mfma_f32_16x16x32_bf16 v[12:15], v[188:191], v[76:79], v[12:15]
  s_nop 2
  ds_write_b32 v112, v100 offset:768
  s_waitcnt lgkmcnt(2)
  v_mfma_f32_16x16x32_bf16 v[0:3], v[192:195], v[80:83], v[0:3]
  s_waitcnt lgkmcnt(0)
  s_barrier
  ds_read_b128 v[64:67], v109 offset:29184
  ds_read_b128 v[68:71], v109 offset:30208
  ds_read_b128 v[72:75], v109 offset:31232
  ds_read_b128 v[76:79], v109 offset:32256
  ds_read_b128 v[100:103], v111 offset:768
  v_mfma_f32_16x16x32_bf16 v[0:3], v[208:211], v[84:87], v[0:3]
  v_mul_f32 v54, v118, v54
  v_mul_f32 v55, v118, v55
  v_mfma_f32_16x16x32_bf16 v[0:3], v[224:227], v[88:91], v[0:3]
  v_cvt_pk_bf16_f32 v50, v52, v53
  v_cvt_pk_bf16_f32 v51, v54, v55
  v_mfma_f32_16x16x32_bf16 v[0:3], v[240:243], v[92:95], v[0:3]
  v_mul_f32_dpp v56, v56, v126 row_ror:8 row_mask:0xf bank_mask:0xf
  v_mul_f32_dpp v57, v57, v126 row_ror:8 row_mask:0xf bank_mask:0xf
  v_mfma_f32_16x16x32_bf16 v[4:7], v[196:199], v[80:83], v[4:7]
  v_mul_f32_dpp v58, v58, v126 row_ror:8 row_mask:0xf bank_mask:0xf
  v_mul_f32_dpp v59, v59, v126 row_ror:8 row_mask:0xf bank_mask:0xf
  v_mfma_f32_16x16x32_bf16 v[4:7], v[212:215], v[84:87], v[4:7]
  v_cvt_pk_bf16_f32 v56, v56, v57
  v_mul_f32_dpp v60, v60, v126 row_ror:8 row_mask:0xf bank_mask:0xf
  v_mfma_f32_16x16x32_bf16 v[4:7], v[228:231], v[88:91], v[4:7]
  v_mul_f32_dpp v61, v61, v126 row_ror:8 row_mask:0xf bank_mask:0xf
  v_cvt_pk_bf16_f32 v57, v58, v59
  v_mfma_f32_16x16x32_bf16 v[4:7], v[244:247], v[92:95], v[4:7]
  v_mul_f32_dpp v62, v62, v126 row_ror:8 row_mask:0xf bank_mask:0xf
  v_mul_f32_dpp v63, v63, v126 row_ror:8 row_mask:0xf bank_mask:0xf
  v_mfma_f32_16x16x32_bf16 v[8:11], v[200:203], v[80:83], v[8:11]
  v_cvt_pk_bf16_f32 v58, v60, v61
  v_cvt_pk_bf16_f32 v59, v62, v63
  v_mfma_f32_16x16x32_bf16 v[8:11], v[216:219], v[84:87], v[8:11]
  v_cndmask_b32_e64 v52, v48, v56, s[88:89]
  v_cndmask_b32_e64 v53, v49, v57, s[88:89]
  v_mfma_f32_16x16x32_bf16 v[8:11], v[232:235], v[88:91], v[8:11]
  v_cndmask_b32_e64 v54, v50, v58, s[88:89]
  v_cndmask_b32_e64 v55, v51, v59, s[88:89]
  v_mfma_f32_16x16x32_bf16 v[8:11], v[248:251], v[92:95], v[8:11]
  v_cndmask_b32_e64 v60, v56, v48, s[88:89]
  v_cndmask_b32_e64 v61, v57, v49, s[88:89]
  v_mfma_f32_16x16x32_bf16 v[12:15], v[204:207], v[80:83], v[12:15]
  v_cndmask_b32_e64 v62, v58, v50, s[88:89]
  v_cndmask_b32_e64 v63, v59, v51, s[88:89]
  v_mfma_f32_16x16x32_bf16 v[12:15], v[220:223], v[84:87], v[12:15]
  buffer_store_dwordx4 v[52:55], v114, s[20:23], s27 offen offset:0 sc1
  v_mfma_f32_16x16x32_bf16 v[12:15], v[236:239], v[88:91], v[12:15]
  v_mfma_f32_16x16x32_bf16 v[12:15], v[252:255], v[92:95], v[12:15]
  s_waitcnt lgkmcnt(1)
  v_mfma_f32_16x16x32_bf16 v[24:27], a[192:195], v[64:67], 0
  v_mfma_f32_16x16x32_bf16 v[24:27], a[208:211], v[68:71], v[24:27]
  ds_read_b128 v[80:83], v109 offset:33280
  ds_read_b128 v[84:87], v109 offset:34304
  v_mfma_f32_16x16x32_bf16 v[24:27], a[224:227], v[72:75], v[24:27]
  ds_read_b128 v[88:91], v109 offset:35328
  ds_read_b128 v[92:95], v109 offset:36352
  v_mfma_f32_16x16x32_bf16 v[24:27], a[240:243], v[76:79], v[24:27]
  buffer_store_dwordx4 v[60:63], v127, s[20:23], s27 offen offset:0 sc1
  v_mfma_f32_16x16x32_bf16 v[28:31], a[196:199], v[64:67], 0
  s_add_u32 s27, s27, 8192
  v_mfma_f32_16x16x32_bf16 v[28:31], a[212:215], v[68:71], v[28:31]
  v_rcp_f32 v118, v117
  v_mfma_f32_16x16x32_bf16 v[28:31], a[228:231], v[72:75], v[28:31]
  s_nop 0
  v_mov_b32_dpp v126, v118 row_ror:8 row_mask:0xf bank_mask:0xf
  s_waitcnt lgkmcnt(4)
  v_add_f32 v100, v100, v101
  v_mfma_f32_16x16x32_bf16 v[28:31], a[244:247], v[76:79], v[28:31]
  v_add_f32 v102, v102, v103
  v_add_f32 v115, v100, v102
  v_mfma_f32_16x16x32_bf16 v[32:35], a[200:203], v[64:67], 0
  v_mul_f32 v0, v118, v0
  v_mul_f32 v1, v118, v1
  v_mfma_f32_16x16x32_bf16 v[32:35], a[216:219], v[68:71], v[32:35]
  v_mul_f32 v2, v118, v2
  v_mul_f32 v3, v118, v3
  v_mfma_f32_16x16x32_bf16 v[32:35], a[232:235], v[72:75], v[32:35]
  v_cvt_pk_bf16_f32 v0, v0, v1
  v_mul_f32 v4, v118, v4
  v_mfma_f32_16x16x32_bf16 v[32:35], a[248:251], v[76:79], v[32:35]
  v_mul_f32 v5, v118, v5
  v_cvt_pk_bf16_f32 v1, v2, v3
  v_mfma_f32_16x16x32_bf16 v[36:39], a[204:207], v[64:67], 0
  v_mul_f32 v6, v118, v6
  v_mul_f32 v7, v118, v7
  v_mfma_f32_16x16x32_bf16 v[36:39], a[220:223], v[68:71], v[36:39]
  v_cvt_pk_bf16_f32 v2, v4, v5
  v_cvt_pk_bf16_f32 v3, v6, v7
  v_mfma_f32_16x16x32_bf16 v[36:39], a[236:239], v[72:75], v[36:39]
  v_mul_f32_dpp v8, v8, v126 row_ror:8 row_mask:0xf bank_mask:0xf
  v_mul_f32_dpp v9, v9, v126 row_ror:8 row_mask:0xf bank_mask:0xf
  v_mfma_f32_16x16x32_bf16 v[36:39], a[252:255], v[76:79], v[36:39]
  v_mul_f32_dpp v10, v10, v126 row_ror:8 row_mask:0xf bank_mask:0xf
  v_mul_f32_dpp v11, v11, v126 row_ror:8 row_mask:0xf bank_mask:0xf
  s_waitcnt lgkmcnt(0)
  v_mfma_f32_16x16x32_bf16 v[24:27], v[128:131], v[80:83], v[24:27]
  v_cvt_pk_bf16_f32 v8, v8, v9
  v_mul_f32_dpp v12, v12, v126 row_ror:8 row_mask:0xf bank_mask:0xf
  v_mfma_f32_16x16x32_bf16 v[24:27], v[144:147], v[84:87], v[24:27]
  ds_read_b128 v[64:67], v109 offset:37376
  ds_read_b128 v[68:71], v109 offset:38400
  v_mfma_f32_16x16x32_bf16 v[24:27], v[160:163], v[88:91], v[24:27]
  ds_read_b128 v[72:75], v109 offset:39424
  ds_read_b128 v[76:79], v109 offset:40448
  v_mfma_f32_16x16x32_bf16 v[24:27], v[176:179], v[92:95], v[24:27]
  v_mul_f32_dpp v13, v13, v126 row_ror:8 row_mask:0xf bank_mask:0xf
  v_cvt_pk_bf16_f32 v9, v10, v11
  v_mfma_f32_16x16x32_bf16 v[28:31], v[132:135], v[80:83], v[28:31]
  v_mul_f32_dpp v14, v14, v126 row_ror:8 row_mask:0xf bank_mask:0xf
  v_mul_f32_dpp v15, v15, v126 row_ror:8 row_mask:0xf bank_mask:0xf
  v_mfma_f32_16x16x32_bf16 v[28:31], v[148:151], v[84:87], v[28:31]
  v_cvt_pk_bf16_f32 v10, v12, v13
  v_cvt_pk_bf16_f32 v11, v14, v15
  v_mfma_f32_16x16x32_bf16 v[28:31], v[164:167], v[88:91], v[28:31]
  v_cndmask_b32_e64 v4, v0, v8, s[88:89]
  v_cndmask_b32_e64 v5, v1, v9, s[88:89]
  v_mfma_f32_16x16x32_bf16 v[28:31], v[180:183], v[92:95], v[28:31]
  v_cndmask_b32_e64 v6, v2, v10, s[88:89]
  v_cndmask_b32_e64 v7, v3, v11, s[88:89]
  v_mfma_f32_16x16x32_bf16 v[32:35], v[136:139], v[80:83], v[32:35]
  v_cndmask_b32_e64 v12, v8, v0, s[88:89]
  v_cndmask_b32_e64 v13, v9, v1, s[88:89]
  v_mfma_f32_16x16x32_bf16 v[32:35], v[152:155], v[84:87], v[32:35]
  v_cndmask_b32_e64 v14, v10, v2, s[88:89]
  v_cndmask_b32_e64 v15, v11, v3, s[88:89]
  v_mfma_f32_16x16x32_bf16 v[32:35], v[168:171], v[88:91], v[32:35]
  buffer_store_dwordx4 v[4:7], v114, s[20:23], s27 offen offset:0 sc1
  v_mfma_f32_16x16x32_bf16 v[32:35], v[184:187], v[92:95], v[32:35]
  v_mfma_f32_16x16x32_bf16 v[36:39], v[140:143], v[80:83], v[36:39]
  v_mfma_f32_16x16x32_bf16 v[36:39], v[156:159], v[84:87], v[36:39]
  v_mfma_f32_16x16x32_bf16 v[36:39], v[172:175], v[88:91], v[36:39]
  buffer_store_dwordx4 v[12:15], v127, s[20:23], s27 offen offset:0 sc1
  v_mfma_f32_16x16x32_bf16 v[36:39], v[188:191], v[92:95], v[36:39]
  s_add_u32 s27, s27, 8192
  s_waitcnt lgkmcnt(0)
  v_mfma_f32_16x16x32_bf16 v[24:27], v[192:195], v[64:67], v[24:27]
  v_rcp_f32 v118, v115
  v_mfma_f32_16x16x32_bf16 v[24:27], v[208:211], v[68:71], v[24:27]
  s_nop 0
  v_mov_b32_dpp v126, v118 row_ror:8 row_mask:0xf bank_mask:0xf
  v_mfma_f32_16x16x32_bf16 v[24:27], v[224:227], v[72:75], v[24:27]
  v_mfma_f32_16x16x32_bf16 v[24:27], v[240:243], v[76:79], v[24:27]
  v_mfma_f32_16x16x32_bf16 v[28:31], v[196:199], v[64:67], v[28:31]
  v_mfma_f32_16x16x32_bf16 v[28:31], v[212:215], v[68:71], v[28:31]
  v_mfma_f32_16x16x32_bf16 v[28:31], v[228:231], v[72:75], v[28:31]
  v_mfma_f32_16x16x32_bf16 v[28:31], v[244:247], v[76:79], v[28:31]
  v_mfma_f32_16x16x32_bf16 v[32:35], v[200:203], v[64:67], v[32:35]
  v_mfma_f32_16x16x32_bf16 v[32:35], v[216:219], v[68:71], v[32:35]
  v_mfma_f32_16x16x32_bf16 v[32:35], v[232:235], v[72:75], v[32:35]
  v_mfma_f32_16x16x32_bf16 v[32:35], v[248:251], v[76:79], v[32:35]
  v_mfma_f32_16x16x32_bf16 v[36:39], v[204:207], v[64:67], v[36:39]
  v_mfma_f32_16x16x32_bf16 v[36:39], v[220:223], v[68:71], v[36:39]
  v_mfma_f32_16x16x32_bf16 v[36:39], v[236:239], v[72:75], v[36:39]
  v_mfma_f32_16x16x32_bf16 v[36:39], v[252:255], v[76:79], v[36:39]
  v_mul_f32 v24, v118, v24
  v_mul_f32 v25, v118, v25
  v_mul_f32 v26, v118, v26
  v_mul_f32 v27, v118, v27
  v_cvt_pk_bf16_f32 v24, v24, v25
  v_mul_f32 v28, v118, v28
  v_mul_f32 v29, v118, v29
  v_cvt_pk_bf16_f32 v25, v26, v27
  v_mul_f32 v30, v118, v30
  v_mul_f32 v31, v118, v31
  v_cvt_pk_bf16_f32 v26, v28, v29
  v_cvt_pk_bf16_f32 v27, v30, v31
  v_mul_f32_dpp v32, v32, v126 row_ror:8 row_mask:0xf bank_mask:0xf
  v_mul_f32_dpp v33, v33, v126 row_ror:8 row_mask:0xf bank_mask:0xf
  v_mul_f32_dpp v34, v34, v126 row_ror:8 row_mask:0xf bank_mask:0xf
  v_mul_f32_dpp v35, v35, v126 row_ror:8 row_mask:0xf bank_mask:0xf
  v_cvt_pk_bf16_f32 v32, v32, v33
  v_mul_f32_dpp v36, v36, v126 row_ror:8 row_mask:0xf bank_mask:0xf
  v_mul_f32_dpp v37, v37, v126 row_ror:8 row_mask:0xf bank_mask:0xf
  v_cvt_pk_bf16_f32 v33, v34, v35
  v_mul_f32_dpp v38, v38, v126 row_ror:8 row_mask:0xf bank_mask:0xf
  v_mul_f32_dpp v39, v39, v126 row_ror:8 row_mask:0xf bank_mask:0xf
  v_cvt_pk_bf16_f32 v34, v36, v37
  v_cvt_pk_bf16_f32 v35, v38, v39
  v_cndmask_b32_e64 v28, v24, v32, s[88:89]
  v_cndmask_b32_e64 v29, v25, v33, s[88:89]
  v_cndmask_b32_e64 v30, v26, v34, s[88:89]
  v_cndmask_b32_e64 v31, v27, v35, s[88:89]
  buffer_store_dwordx4 v[28:31], v114, s[20:23], s27 offen offset:0 sc1
  v_cndmask_b32_e64 v36, v32, v24, s[88:89]
  v_cndmask_b32_e64 v37, v33, v25, s[88:89]
  v_cndmask_b32_e64 v38, v34, v26, s[88:89]
  v_cndmask_b32_e64 v39, v35, v27, s[88:89]
  buffer_store_dwordx4 v[36:39], v127, s[20:23], s27 offen offset:0 sc1
  L_done:
  s_endpgm
.section .rodata,"a"
.p2align 6
.amdhsa_kernel standalone__gqa_softmax__near_ridge_kernel
  .amdhsa_next_free_vgpr 512
  .amdhsa_next_free_sgpr 102
  .amdhsa_accum_offset 256
  .amdhsa_group_segment_fixed_size 0
  .amdhsa_kernarg_size 48
  .amdhsa_user_sgpr_count 2
  .amdhsa_user_sgpr_kernarg_segment_ptr 1
  .amdhsa_system_sgpr_workgroup_id_x 1
.end_amdhsa_kernel
```
